```python
import torch

def _softmax(x, axis=-1):
    return torch.softmax(x, dim=axis)
def _gelu(x):
    return torch.nn.functional.gelu(x, approximate="tanh")
def _silu(x):
    return torch.nn.functional.silu(x)
def _sigmoid(x):
    return torch.sigmoid(x)
def _layernorm(x, axis=-1, eps=1e-5):
    m = x.mean(dim=axis, keepdim=True)
    v = x.var(dim=axis, keepdim=True, unbiased=False)
    return (x - m) / torch.sqrt(v + eps)
def _scatter_add(tgt, idx, src, axis=0):
    return tgt.clone().index_add_(axis, idx, src)
def _segment_sum(src, seg, n):
    out = torch.zeros((n,) + src.shape[1:], dtype=src.dtype)
    return out.index_add_(0, seg, src)
def _pad(x, pw):
    flat = tuple(v for pair in reversed(pw) for v in pair)
    return torch.nn.functional.pad(x, flat)

kernel_name = 'standalone__gqa_softmax__near_ridge'

def setup_inputs():

    _w = (lambda a: (lambda t: t.to(torch.bfloat16) if t.is_floating_point() else t)(torch.as_tensor(a)))
    B, Hq, Hkv, Sq, Sk, D = 16, 32, 32, 384, 512, 128
    return {
        "q": _w((lambda *s: torch.randn(*s, dtype=torch.bfloat16) * 0.8)(B, Hq, Sq, D)),
        "k": _w((lambda *s: torch.randn(*s, dtype=torch.bfloat16) * 0.8)(B, Hkv, Sk, D)),
        "v": _w((lambda *s: torch.randn(*s, dtype=torch.bfloat16) * 0.05)(B, Hkv, Sk, D)),
    }

def reference(q, k, v):
    B, Hq, Sq, D = q.shape
    Hkv = k.shape[1]
    rep = Hq // Hkv
    k = (lambda x, n, axis: torch.repeat_interleave(x, n, dim=axis))(k, rep, axis=1)
    v = (lambda x, n, axis: torch.repeat_interleave(x, n, dim=axis))(v, rep, axis=1)
    scale = D ** -0.5
    scores = torch.einsum("bhqd,bhkd->bhqk", q, k) * scale
    p = _softmax(scores, axis=-1)
    return torch.einsum("bhqk,bhkd->bhqd", p, v)
```

```asm
; @launch grid=(256,1,1) block=(256,1,1) lds=163840
.amdgcn_target "amdgcn-amd-amdhsa--gfx950"
.text
.globl standalone__gqa_softmax__near_ridge_kernel
.p2align 8
.type standalone__gqa_softmax__near_ridge_kernel,@function
standalone__gqa_softmax__near_ridge_kernel:
    s_cmp_ge_u32 s2, 256
    s_cbranch_scc1 L_end
    s_load_dwordx4 s[16:19], s[0:1], 0
    s_load_dwordx4 s[24:27], s[0:1], 16
    s_getpc_b64 s[76:77]
L_pc:
    s_getreg_b32 s39, hwreg(HW_REG_HW_ID, 8, 4)
    s_getreg_b32 s45, hwreg(HW_REG_HW_ID, 13, 2)
    s_lshl_b32 s45, s45, 3
    s_add_u32 s39, s39, s45
    s_lshl_b32 s39, s39, 10
    s_sub_u32 s39, s39, 1024
    v_lshl_add_u32 v24, v0, 3, s39
    v_max_i32 v24, 0, v24
    v_min_u32 v24, L_fallback-L_pc, v24
    global_load_dword v255, v24, s[76:77]
    v_lshrrev_b32 v22, 6, v0
    v_and_b32 v0, 63, v0
    v_readfirstlane_b32 s28, v22
    v_lshrrev_b32 v22, 4, v0
    v_and_b32 v23, 15, v0
    v_lshlrev_b32 v24, 1, v22
    v_xor_b32 v24, v24, v23
    v_lshlrev_b32 v24, 4, v24
    v_lshl_add_u32 v2, v22, 8, v24
    v_xor_b32 v3, 0x80, v2
    s_lshl_b32 s29, s28, 13
    s_lshl_b32 s98, s28, 14
    s_lshl_b32 s39, s2, 1
    s_mul_i32 s54, s39, 98304
    s_mul_i32 s45, s28, 24576
    s_add_u32 s54, s54, s45
    s_lshl_b32 s55, s39, 17
    s_lshl_b32 s45, s28, 12
    s_add_u32 s55, s55, s45
    s_waitcnt lgkmcnt(0)
    s_mov_b32 s20, s18
    s_and_b32 s21, s19, 0xffff
    s_mov_b32 s22, 67108864
    s_mov_b32 s23, 0x20000
    s_and_b32 s17, s17, 0xffff
    s_mov_b32 s18, 50331648
    s_mov_b32 s19, 0x20000
    s_mov_b32 m0, s29
    s_mov_b32 s12, s26
    s_getreg_b32 s100, hwreg(HW_REG_XCC_ID, 0, 1)
    s_getreg_b32 s101, hwreg(HW_REG_HW_ID, 8, 1)
    s_lshl_b32 s100, s100, 1
    s_or_b32 s100, s100, s101
    s_and_b32 s100, s100, 3
    buffer_load_dwordx4 v2, s[20:23], s55 offen offset:0 nt lds
    buffer_load_dwordx4 v3, s[20:23], s55 offen offset:1024 nt lds
    buffer_load_dwordx4 v2, s[20:23], s55 offen offset:2048 nt lds
    buffer_load_dwordx4 v3, s[20:23], s55 offen offset:3072 nt lds
    s_bitcmp1_b32 0xb, s100
    s_cbranch_scc0 L_nh0
    s_waitcnt vmcnt(0)
L_nh0:
    s_add_u32 m0, s98, 98304
    s_and_b32 s13, s27, 0xffff
    buffer_load_dwordx4 v2, s[16:19], s54 offen offset:0 nt lds
    buffer_load_dwordx4 v3, s[16:19], s54 offen offset:1024 nt lds
    buffer_load_dwordx4 v2, s[16:19], s54 offen offset:2048 nt lds
    buffer_load_dwordx4 v3, s[16:19], s54 offen offset:3072 nt lds
    s_bitcmp1_b32 0xb, s100
    s_cbranch_scc0 L_nh1
    s_waitcnt vmcnt(0)
L_nh1:
    s_and_b32 s25, s25, 0xffff
    s_mov_b32 s26, 67108864
    s_mov_b32 s27, 0x20000
    s_add_u32 m0, s29, 4096
    s_mov_b32 s14, 50331648
    buffer_load_dwordx4 v2, s[24:27], s55 offen offset:0 nt lds
    buffer_load_dwordx4 v3, s[24:27], s55 offen offset:1024 nt lds
    buffer_load_dwordx4 v2, s[24:27], s55 offen offset:2048 nt lds
    buffer_load_dwordx4 v3, s[24:27], s55 offen offset:3072 nt lds
    s_bitcmp1_b32 0xb, s100
    s_cbranch_scc0 L_nh2
    s_waitcnt vmcnt(0)
L_nh2:
    s_add_u32 m0, s98, 102400
    s_add_u32 s39, s54, 4096
    buffer_load_dwordx4 v2, s[16:19], s39 offen offset:0 nt lds
    buffer_load_dwordx4 v3, s[16:19], s39 offen offset:1024 nt lds
    buffer_load_dwordx4 v2, s[16:19], s39 offen offset:2048 nt lds
    buffer_load_dwordx4 v3, s[16:19], s39 offen offset:3072 nt lds
    s_bitcmp1_b32 0xa, s100
    s_cbranch_scc0 L_nh3
    s_waitcnt vmcnt(0)
L_nh3:
    s_mov_b32 s15, 0x20000
    s_mov_b64 s[4:5], s[20:21]
    s_lshl_b32 s6, s2, 18
    s_add_u32 s6, s6, 262144
    s_mov_b32 s7, 0x20000
    s_mov_b64 s[8:9], s[24:25]
    s_mov_b32 s10, s6
    s_add_u32 s52, s16, 4096
    s_addc_u32 s53, s17, 0
    s_mov_b32 s11, 0x20000
    s_add_u32 s30, s55, 16384
    s_add_u32 s95, s98, 98304
    s_add_u32 s39, s54, 98304
    s_add_u32 s86, s98, 98304
    s_add_u32 s84, s16, s39
    s_addc_u32 s85, s17, 0
    s_sub_u32 s84, s84, s86
    s_subb_u32 s85, s85, 0
    s_add_u32 s86, s86, 16384
    s_mov_b32 s87, 0x20000
    s_add_u32 s57, s29, 65536
    s_mov_b32 s37, 0
    s_mov_b32 s32, 0xffff0000
    s_mov_b32 s38, 0x3e0293ee
    s_mov_b32 s40, s54
    s_add_u32 s42, s54, 114688
    s_add_u32 s41, s55, 131072
    s_mov_b32 s48, 0
    s_mov_b32 s50, 0x3a800000
    s_mov_b32 s51, 0x19000000
    v_and_b32 v24, 7, v23
    v_lshlrev_b32 v24, 1, v24
    v_xor_b32 v24, v24, v22
    v_lshlrev_b32 v24, 4, v24
    v_lshl_add_u32 v24, v23, 8, v24
    v_mov_b32 v4, v24
    v_xor_b32 v5, 64, v4
    v_xor_b32 v6, 128, v4
    v_xor_b32 v7, 192, v4
    v_lshrrev_b32 v24, 2, v0
    v_and_b32 v25, 7, v24
    v_lshlrev_b32 v25, 5, v25
    v_lshl_add_u32 v25, v24, 8, v25
    v_and_b32 v26, 3, v0
    v_lshl_add_u32 v25, v26, 3, v25
    v_add_u32 v8, 4096, v25
    v_xor_b32 v9, 32, v8
    v_xor_b32 v10, 64, v8
    v_xor_b32 v11, 96, v8
    v_xor_b32 v12, 128, v8
    v_xor_b32 v13, 160, v8
    v_xor_b32 v14, 192, v8
    v_xor_b32 v15, 224, v8
    v_mov_b32 v25, 0x3f803f80
    v_cmp_eq_u32 vcc, 0, v26
    s_nop 1
    v_cndmask_b32 v25, 0, v25, vcc
    v_accvgpr_write_b32 a248, v25
    v_accvgpr_write_b32 a249, v25
    v_accvgpr_write_b32 a250, v25
    v_accvgpr_write_b32 a251, v25
    s_add_u32 s39, s98, 98304
    v_lshl_add_u32 v1, v0, 4, s39
    s_add_u32 s49, s98, 98304
    v_add_u32 v224, s49, v4
    v_add_u32 v225, s49, v5
    v_add_u32 v226, s49, v6
    v_add_u32 v227, s49, v7
    s_mov_b32 s35, 0
    s_mov_b32 s97, 5
    s_mov_b32 s34, 32768
    s_add_u32 s99, s29, 32768
    s_waitcnt vmcnt(4)
    s_barrier
    ds_read_b128 v[232:235], v224 offset:0
    ds_read_b128 v[236:239], v225 offset:0
    ds_read_b128 v[240:243], v226 offset:0
    ds_read_b128 v[244:247], v227 offset:0
    ds_read_b128 a[96:99], v4 offset:0
    ds_read_b128 a[100:103], v5 offset:0
    ds_read_b128 a[104:107], v6 offset:0
    ds_read_b128 a[108:111], v7 offset:0
    ds_read_b128 a[112:115], v4 offset:8192
    ds_read_b128 a[116:119], v5 offset:8192
    ds_read_b128 a[120:123], v6 offset:8192
    ds_read_b128 a[124:127], v7 offset:8192
    s_add_u32 m0, s98, 106496
    s_add_u32 s39, s54, 8192
    buffer_load_dwordx4 v2, s[16:19], s39 offen offset:0 nt lds
    buffer_load_dwordx4 v3, s[16:19], s39 offen offset:1024 nt lds
    buffer_load_dwordx4 v2, s[16:19], s39 offen offset:2048 nt lds
    buffer_load_dwordx4 v3, s[16:19], s39 offen offset:3072 nt lds
    s_bitcmp1_b32 0x2, s100
    s_cbranch_scc0 L_nh4
    s_waitcnt vmcnt(0)
L_nh4:
    s_waitcnt lgkmcnt(8)
    s_add_u32 m0, s98, 110592
    s_add_u32 s39, s54, 12288
    buffer_load_dwordx4 v2, s[16:19], s39 offen offset:0 nt lds
    v_lshlrev_b32 v248, 16, v232
    v_and_b32 v249, 0xffff0000, v232
    v_pk_mul_f32 v[248:249], v[248:249], s[38:39] op_sel_hi:[1,0]
    v_cvt_pk_bf16_f32 v232, v248, v249
    v_accvgpr_write_b32 a0, v232
    v_lshlrev_b32 v250, 16, v233
    v_and_b32 v251, 0xffff0000, v233
    v_pk_mul_f32 v[250:251], v[250:251], s[38:39] op_sel_hi:[1,0]
    v_cvt_pk_bf16_f32 v233, v250, v251
    v_accvgpr_write_b32 a1, v233
    buffer_load_dwordx4 v3, s[16:19], s39 offen offset:1024 nt lds
    v_lshlrev_b32 v248, 16, v234
    v_and_b32 v249, 0xffff0000, v234
    v_pk_mul_f32 v[248:249], v[248:249], s[38:39] op_sel_hi:[1,0]
    v_cvt_pk_bf16_f32 v234, v248, v249
    v_accvgpr_write_b32 a2, v234
    v_lshlrev_b32 v250, 16, v235
    v_and_b32 v251, 0xffff0000, v235
    v_pk_mul_f32 v[250:251], v[250:251], s[38:39] op_sel_hi:[1,0]
    v_cvt_pk_bf16_f32 v235, v250, v251
    v_accvgpr_write_b32 a3, v235
    buffer_load_dwordx4 v2, s[16:19], s39 offen offset:2048 nt lds
    v_lshlrev_b32 v248, 16, v236
    v_and_b32 v249, 0xffff0000, v236
    v_pk_mul_f32 v[248:249], v[248:249], s[38:39] op_sel_hi:[1,0]
    v_cvt_pk_bf16_f32 v236, v248, v249
    v_accvgpr_write_b32 a4, v236
    v_lshlrev_b32 v250, 16, v237
    v_and_b32 v251, 0xffff0000, v237
    v_pk_mul_f32 v[250:251], v[250:251], s[38:39] op_sel_hi:[1,0]
    v_cvt_pk_bf16_f32 v237, v250, v251
    v_accvgpr_write_b32 a5, v237
    buffer_load_dwordx4 v3, s[16:19], s39 offen offset:3072 nt lds
    v_lshlrev_b32 v248, 16, v238
    v_and_b32 v249, 0xffff0000, v238
    v_pk_mul_f32 v[248:249], v[248:249], s[38:39] op_sel_hi:[1,0]
    v_cvt_pk_bf16_f32 v238, v248, v249
    v_accvgpr_write_b32 a6, v238
    v_lshlrev_b32 v250, 16, v239
    v_and_b32 v251, 0xffff0000, v239
    v_pk_mul_f32 v[250:251], v[250:251], s[38:39] op_sel_hi:[1,0]
    v_cvt_pk_bf16_f32 v239, v250, v251
    v_accvgpr_write_b32 a7, v239
    s_bitcmp1_b32 0x2, s100
    s_cbranch_scc0 L_nh5
    s_waitcnt vmcnt(0)
L_nh5:
    s_add_u32 m0, s29, 65536
    s_add_u32 s39, s54, 16384
    buffer_load_dwordx4 v2, s[16:19], s39 offen offset:0 nt lds
    v_lshlrev_b32 v248, 16, v240
    v_and_b32 v249, 0xffff0000, v240
    v_pk_mul_f32 v[248:249], v[248:249], s[38:39] op_sel_hi:[1,0]
    v_cvt_pk_bf16_f32 v240, v248, v249
    v_accvgpr_write_b32 a8, v240
    v_lshlrev_b32 v250, 16, v241
    v_and_b32 v251, 0xffff0000, v241
    v_pk_mul_f32 v[250:251], v[250:251], s[38:39] op_sel_hi:[1,0]
    v_cvt_pk_bf16_f32 v241, v250, v251
    v_accvgpr_write_b32 a9, v241
    buffer_load_dwordx4 v3, s[16:19], s39 offen offset:1024 nt lds
    v_lshlrev_b32 v248, 16, v242
    v_and_b32 v249, 0xffff0000, v242
    v_pk_mul_f32 v[248:249], v[248:249], s[38:39] op_sel_hi:[1,0]
    v_cvt_pk_bf16_f32 v242, v248, v249
    v_accvgpr_write_b32 a10, v242
    v_lshlrev_b32 v250, 16, v243
    v_and_b32 v251, 0xffff0000, v243
    v_pk_mul_f32 v[250:251], v[250:251], s[38:39] op_sel_hi:[1,0]
    v_cvt_pk_bf16_f32 v243, v250, v251
    v_accvgpr_write_b32 a11, v243
    buffer_load_dwordx4 v2, s[16:19], s39 offen offset:2048 nt lds
    v_lshlrev_b32 v248, 16, v244
    v_and_b32 v249, 0xffff0000, v244
    v_pk_mul_f32 v[248:249], v[248:249], s[38:39] op_sel_hi:[1,0]
    v_cvt_pk_bf16_f32 v244, v248, v249
    v_accvgpr_write_b32 a12, v244
    v_lshlrev_b32 v250, 16, v245
    v_and_b32 v251, 0xffff0000, v245
    v_pk_mul_f32 v[250:251], v[250:251], s[38:39] op_sel_hi:[1,0]
    v_cvt_pk_bf16_f32 v245, v250, v251
    v_accvgpr_write_b32 a13, v245
    buffer_load_dwordx4 v3, s[16:19], s39 offen offset:3072 nt lds
    v_lshlrev_b32 v248, 16, v246
    v_and_b32 v249, 0xffff0000, v246
    v_pk_mul_f32 v[248:249], v[248:249], s[38:39] op_sel_hi:[1,0]
    v_cvt_pk_bf16_f32 v246, v248, v249
    v_accvgpr_write_b32 a14, v246
    v_lshlrev_b32 v250, 16, v247
    v_and_b32 v251, 0xffff0000, v247
    v_pk_mul_f32 v[250:251], v[250:251], s[38:39] op_sel_hi:[1,0]
    v_cvt_pk_bf16_f32 v247, v250, v251
    v_accvgpr_write_b32 a15, v247
    s_bitcmp1_b32 0x2, s100
    s_cbranch_scc0 L_nh6
    s_waitcnt vmcnt(0)
L_nh6:
    s_waitcnt lgkmcnt(0)
    v_mfma_f32_16x16x32_bf16 v[32:35], a[96:99], a[0:3], 0
    ds_read_b128 a[128:131], v4 offset:16384
    v_mfma_f32_16x16x32_bf16 v[32:35], a[100:103], a[4:7], v[32:35]
    ds_read_b128 a[132:135], v5 offset:16384
    v_mfma_f32_16x16x32_bf16 v[32:35], a[104:107], a[8:11], v[32:35]
    ds_read_b128 a[136:139], v6 offset:16384
    v_mfma_f32_16x16x32_bf16 v[32:35], a[108:111], a[12:15], v[32:35]
    ds_read_b128 a[140:143], v7 offset:16384
    v_mfma_f32_16x16x32_bf16 v[36:39], a[112:115], a[0:3], 0
    ds_read_b128 a[144:147], v4 offset:24576
    v_mfma_f32_16x16x32_bf16 v[36:39], a[116:119], a[4:7], v[36:39]
    ds_read_b128 a[148:151], v5 offset:24576
    v_mfma_f32_16x16x32_bf16 v[36:39], a[120:123], a[8:11], v[36:39]
    ds_read_b128 a[152:155], v6 offset:24576
    v_mfma_f32_16x16x32_bf16 v[36:39], a[124:127], a[12:15], v[36:39]
    ds_read_b128 a[156:159], v7 offset:24576
    s_waitcnt lgkmcnt(0)
    v_mfma_f32_16x16x32_bf16 v[40:43], a[128:131], a[0:3], 0
    ds_read_b64_tr_b16 a[160:161], v8 offset:0
    ds_read_b64_tr_b16 a[162:163], v8 offset:8192
    ds_read_b64_tr_b16 a[164:165], v9 offset:0
    ds_read_b64_tr_b16 a[166:167], v9 offset:8192
    v_mfma_f32_16x16x32_bf16 v[40:43], a[132:135], a[4:7], v[40:43]
    ds_read_b64_tr_b16 a[192:193], v8 offset:16384
    ds_read_b64_tr_b16 a[194:195], v8 offset:24576
    ds_read_b64_tr_b16 a[196:197], v9 offset:16384
    ds_read_b64_tr_b16 a[198:199], v9 offset:24576
    v_max3_f32 v228, v32, v33, v34
    v_max3_f32 v228, v228, v35, v36
    v_mfma_f32_16x16x32_bf16 v[40:43], a[136:139], a[8:11], v[40:43]
    ds_read_b64_tr_b16 a[168:169], v10 offset:0
    ds_read_b64_tr_b16 a[170:171], v10 offset:8192
    ds_read_b64_tr_b16 a[172:173], v11 offset:0
    ds_read_b64_tr_b16 a[174:175], v11 offset:8192
    v_max3_f32 v228, v228, v37, v38
    v_max_f32 v228, v228, v39
    v_mfma_f32_16x16x32_bf16 v[40:43], a[140:143], a[12:15], v[40:43]
    ds_read_b64_tr_b16 a[200:201], v10 offset:16384
    ds_read_b64_tr_b16 a[202:203], v10 offset:24576
    ds_read_b64_tr_b16 a[204:205], v11 offset:16384
    ds_read_b64_tr_b16 a[206:207], v11 offset:24576
    v_mov_b32 v229, v228
    v_mfma_f32_16x16x32_bf16 v[44:47], a[144:147], a[0:3], 0
    ds_read_b64_tr_b16 a[176:177], v12 offset:0
    ds_read_b64_tr_b16 a[178:179], v12 offset:8192
    ds_read_b64_tr_b16 a[180:181], v13 offset:0
    ds_read_b64_tr_b16 a[182:183], v13 offset:8192
    v_permlane32_swap_b32 v228, v229
    v_max_f32 v228, v228, v229
    v_mov_b32 v229, v228
    v_mfma_f32_16x16x32_bf16 v[44:47], a[148:151], a[4:7], v[44:47]
    ds_read_b64_tr_b16 a[208:209], v12 offset:16384
    ds_read_b64_tr_b16 a[210:211], v12 offset:24576
    ds_read_b64_tr_b16 a[212:213], v13 offset:16384
    ds_read_b64_tr_b16 a[214:215], v13 offset:24576
    v_permlane16_swap_b32 v228, v229
    v_max_f32 v228, v228, v229
    v_mfma_f32_16x16x32_bf16 v[44:47], a[152:155], a[8:11], v[44:47]
    ds_read_b64_tr_b16 a[184:185], v14 offset:0
    ds_read_b64_tr_b16 a[186:187], v14 offset:8192
    ds_read_b64_tr_b16 a[188:189], v15 offset:0
    ds_read_b64_tr_b16 a[190:191], v15 offset:8192
    v_mul_f32 v16, -1.0, v228
    v_mul_f32 v17, -1.0, v228
    v_mul_f32 v18, -1.0, v228
    v_mul_f32 v19, -1.0, v228
    v_mfma_f32_16x16x32_bf16 v[44:47], a[156:159], a[12:15], v[44:47]
    ds_read_b64_tr_b16 a[216:217], v14 offset:16384
    ds_read_b64_tr_b16 a[218:219], v14 offset:24576
    ds_read_b64_tr_b16 a[220:221], v15 offset:16384
    ds_read_b64_tr_b16 a[222:223], v15 offset:24576
    s_waitcnt vmcnt(12)
    ds_read_b128 v[232:235], v224 offset:4096
    ds_read_b128 v[236:239], v225 offset:4096
    ds_read_b128 v[240:243], v226 offset:4096
    ds_read_b128 v[244:247], v227 offset:4096
    s_add_u32 m0, s29, 32768
    s_nop 0
    buffer_load_dwordx4 v2, s[4:7], s30 offen offset:0 nt lds
    v_add_f32 v32, v32, v16
    v_add_f32 v33, v33, v16
    v_add_f32 v34, v34, v16
    v_add_f32 v35, v35, v16
    v_exp_f32 v32, v32
    v_exp_f32 v33, v33
    v_exp_f32 v34, v34
    v_exp_f32 v35, v35
    v_cvt_pk_bf16_f32 v48, v32, v33
    v_cvt_pk_bf16_f32 v49, v34, v35
    s_waitcnt lgkmcnt(0)
    v_lshlrev_b32 v248, 16, v232
    v_and_b32 v249, 0xffff0000, v232
    v_pk_mul_f32 v[248:249], v[248:249], s[38:39] op_sel_hi:[1,0]
    v_cvt_pk_bf16_f32 v232, v248, v249
    v_accvgpr_write_b32 a16, v232
    v_lshlrev_b32 v250, 16, v233
    v_and_b32 v251, 0xffff0000, v233
    v_pk_mul_f32 v[250:251], v[250:251], s[38:39] op_sel_hi:[1,0]
    v_cvt_pk_bf16_f32 v233, v250, v251
    v_accvgpr_write_b32 a17, v233
    v_lshlrev_b32 v248, 16, v234
    v_and_b32 v249, 0xffff0000, v234
    v_pk_mul_f32 v[248:249], v[248:249], s[38:39] op_sel_hi:[1,0]
    v_cvt_pk_bf16_f32 v234, v248, v249
    v_accvgpr_write_b32 a18, v234
    v_lshlrev_b32 v250, 16, v235
    v_and_b32 v251, 0xffff0000, v235
    v_pk_mul_f32 v[250:251], v[250:251], s[38:39] op_sel_hi:[1,0]
    v_cvt_pk_bf16_f32 v235, v250, v251
    v_accvgpr_write_b32 a19, v235
    v_lshlrev_b32 v248, 16, v236
    v_and_b32 v249, 0xffff0000, v236
    v_pk_mul_f32 v[248:249], v[248:249], s[38:39] op_sel_hi:[1,0]
    v_cvt_pk_bf16_f32 v236, v248, v249
    v_accvgpr_write_b32 a20, v236
    v_lshlrev_b32 v250, 16, v237
    v_and_b32 v251, 0xffff0000, v237
    v_pk_mul_f32 v[250:251], v[250:251], s[38:39] op_sel_hi:[1,0]
    v_cvt_pk_bf16_f32 v237, v250, v251
    v_accvgpr_write_b32 a21, v237
    v_lshlrev_b32 v248, 16, v238
    v_and_b32 v249, 0xffff0000, v238
    v_pk_mul_f32 v[248:249], v[248:249], s[38:39] op_sel_hi:[1,0]
    v_cvt_pk_bf16_f32 v238, v248, v249
    v_accvgpr_write_b32 a22, v238
    v_lshlrev_b32 v250, 16, v239
    v_and_b32 v251, 0xffff0000, v239
    v_pk_mul_f32 v[250:251], v[250:251], s[38:39] op_sel_hi:[1,0]
    v_cvt_pk_bf16_f32 v239, v250, v251
    v_accvgpr_write_b32 a23, v239
    v_lshlrev_b32 v248, 16, v240
    v_and_b32 v249, 0xffff0000, v240
    v_pk_mul_f32 v[248:249], v[248:249], s[38:39] op_sel_hi:[1,0]
    v_cvt_pk_bf16_f32 v240, v248, v249
    v_accvgpr_write_b32 a24, v240
    v_lshlrev_b32 v250, 16, v241
    v_and_b32 v251, 0xffff0000, v241
    v_pk_mul_f32 v[250:251], v[250:251], s[38:39] op_sel_hi:[1,0]
    v_cvt_pk_bf16_f32 v241, v250, v251
    v_accvgpr_write_b32 a25, v241
    v_lshlrev_b32 v248, 16, v242
    v_and_b32 v249, 0xffff0000, v242
    v_pk_mul_f32 v[248:249], v[248:249], s[38:39] op_sel_hi:[1,0]
    v_cvt_pk_bf16_f32 v242, v248, v249
    v_accvgpr_write_b32 a26, v242
    v_lshlrev_b32 v250, 16, v243
    v_and_b32 v251, 0xffff0000, v243
    v_pk_mul_f32 v[250:251], v[250:251], s[38:39] op_sel_hi:[1,0]
    v_cvt_pk_bf16_f32 v243, v250, v251
    v_accvgpr_write_b32 a27, v243
    v_lshlrev_b32 v248, 16, v244
    v_and_b32 v249, 0xffff0000, v244
    v_pk_mul_f32 v[248:249], v[248:249], s[38:39] op_sel_hi:[1,0]
    v_cvt_pk_bf16_f32 v244, v248, v249
    v_accvgpr_write_b32 a28, v244
    v_lshlrev_b32 v250, 16, v245
    v_and_b32 v251, 0xffff0000, v245
    v_pk_mul_f32 v[250:251], v[250:251], s[38:39] op_sel_hi:[1,0]
    v_cvt_pk_bf16_f32 v245, v250, v251
    v_accvgpr_write_b32 a29, v245
    v_lshlrev_b32 v248, 16, v246
    v_and_b32 v249, 0xffff0000, v246
    v_pk_mul_f32 v[248:249], v[248:249], s[38:39] op_sel_hi:[1,0]
    v_cvt_pk_bf16_f32 v246, v248, v249
    v_accvgpr_write_b32 a30, v246
    v_lshlrev_b32 v250, 16, v247
    v_and_b32 v251, 0xffff0000, v247
    v_pk_mul_f32 v[250:251], v[250:251], s[38:39] op_sel_hi:[1,0]
    v_cvt_pk_bf16_f32 v247, v250, v251
    v_accvgpr_write_b32 a31, v247
    v_mfma_f32_16x16x32_bf16 v[32:35], a[96:99], a[16:19], 0
    buffer_load_dwordx4 v3, s[4:7], s30 offen offset:1024 nt lds
    v_add_f32 v36, v36, v16
    v_add_f32 v37, v37, v16
    v_mfma_f32_16x16x32_bf16 v[32:35], a[100:103], a[20:23], v[32:35]
    v_add_f32 v38, v38, v16
    v_add_f32 v39, v39, v16
    v_exp_f32 v36, v36
    v_exp_f32 v37, v37
    v_mfma_f32_16x16x32_bf16 v[32:35], a[104:107], a[24:27], v[32:35]
    v_exp_f32 v38, v38
    v_exp_f32 v39, v39
    v_mfma_f32_16x16x32_bf16 v[32:35], a[108:111], a[28:31], v[32:35]
    v_cvt_pk_bf16_f32 v50, v36, v37
    v_cvt_pk_bf16_f32 v51, v38, v39
    v_mfma_f32_16x16x32_bf16 v[36:39], a[112:115], a[16:19], 0
    buffer_load_dwordx4 v2, s[4:7], s30 offen offset:2048 nt lds
    v_mfma_f32_16x16x32_bf16 v[36:39], a[116:119], a[20:23], v[36:39]
    v_add_f32 v40, v40, v16
    v_add_f32 v41, v41, v16
    v_mfma_f32_16x16x32_bf16 v[36:39], a[120:123], a[24:27], v[36:39]
    v_exp_f32 v40, v40
    v_mfma_f32_16x16x32_bf16 v[36:39], a[124:127], a[28:31], v[36:39]
    v_exp_f32 v41, v41
    v_mfma_f32_16x16x32_bf16 v[64:67], a[160:163], v[48:51], 0
    buffer_load_dwordx4 v3, s[4:7], s30 offen offset:3072 nt lds
    v_cvt_pk_bf16_f32 v52, v40, v41
    v_mfma_f32_16x16x32_bf16 v[68:71], a[164:167], v[48:51], 0
    v_add_f32 v42, v42, v16
    v_add_f32 v43, v43, v16
    v_mfma_f32_16x16x32_bf16 v[72:75], a[168:171], v[48:51], 0
    v_exp_f32 v42, v42
    v_exp_f32 v43, v43
    v_mfma_f32_16x16x32_bf16 v[76:79], a[172:175], v[48:51], 0
    v_max3_f32 v228, v32, v33, v34
    v_max3_f32 v228, v228, v35, v36
    v_cvt_pk_bf16_f32 v53, v42, v43
    v_mfma_f32_16x16x32_bf16 v[80:83], a[176:179], v[48:51], 0
    v_max3_f32 v228, v228, v37, v38
    v_max_f32 v228, v228, v39
    v_mfma_f32_16x16x32_bf16 v[84:87], a[180:183], v[48:51], 0
    v_mov_b32 v229, v228
    v_add_f32 v44, v44, v16
    v_add_f32 v45, v45, v16
    v_mfma_f32_16x16x32_bf16 v[88:91], a[184:187], v[48:51], 0
    v_exp_f32 v44, v44
    v_exp_f32 v45, v45
    v_permlane32_swap_b32 v228, v229
    v_max_f32 v228, v228, v229
    v_mov_b32 v229, v228
    v_mfma_f32_16x16x32_bf16 v[92:95], a[188:191], v[48:51], 0
    v_cvt_pk_bf16_f32 v54, v44, v45
    v_permlane16_swap_b32 v228, v229
    v_max_f32 v228, v228, v229
    v_mfma_f32_16x16x32_bf16 a[224:227], a[248:251], v[48:51], 0
    v_mul_f32 v20, -1.0, v228
    v_mul_f32 v21, -1.0, v228
    v_mul_f32 v22, -1.0, v228
    v_mul_f32 v23, -1.0, v228
    v_mfma_f32_16x16x32_bf16 v[40:43], a[128:131], a[16:19], 0
    v_add_f32 v46, v46, v16
    v_add_f32 v47, v47, v16
    v_mfma_f32_16x16x32_bf16 v[40:43], a[132:135], a[20:23], v[40:43]
    v_exp_f32 v46, v46
    v_exp_f32 v47, v47
    v_mfma_f32_16x16x32_bf16 v[40:43], a[136:139], a[24:27], v[40:43]
    v_cvt_pk_bf16_f32 v55, v46, v47
    v_add_f32 v32, v32, v20
    v_mfma_f32_16x16x32_bf16 v[40:43], a[140:143], a[28:31], v[40:43]
    v_add_f32 v33, v33, v20
    v_exp_f32 v32, v32
    v_mfma_f32_16x16x32_bf16 v[44:47], a[144:147], a[16:19], 0
    v_exp_f32 v33, v33
    v_mfma_f32_16x16x32_bf16 v[44:47], a[148:151], a[20:23], v[44:47]
    v_cvt_pk_bf16_f32 v48, v32, v33
    v_add_f32 v34, v34, v20
    v_mfma_f32_16x16x32_bf16 v[44:47], a[152:155], a[24:27], v[44:47]
    v_add_f32 v35, v35, v20
    v_exp_f32 v34, v34
    v_mfma_f32_16x16x32_bf16 v[44:47], a[156:159], a[28:31], v[44:47]
    v_exp_f32 v35, v35
    v_mfma_f32_16x16x32_bf16 v[64:67], a[192:195], v[52:55], v[64:67]
    v_cvt_pk_bf16_f32 v49, v34, v35
    v_add_f32 v36, v36, v20
    v_mfma_f32_16x16x32_bf16 v[68:71], a[196:199], v[52:55], v[68:71]
    v_add_f32 v37, v37, v20
    v_exp_f32 v36, v36
    v_mfma_f32_16x16x32_bf16 v[72:75], a[200:203], v[52:55], v[72:75]
    v_exp_f32 v37, v37
    v_mfma_f32_16x16x32_bf16 v[76:79], a[204:207], v[52:55], v[76:79]
    s_waitcnt vmcnt(12)
    ds_read_b128 v[232:235], v224 offset:8192
    ds_read_b128 v[236:239], v225 offset:8192
    ds_read_b128 v[240:243], v226 offset:8192
    ds_read_b128 v[244:247], v227 offset:8192
    v_cvt_pk_bf16_f32 v50, v36, v37
    v_mfma_f32_16x16x32_bf16 v[80:83], a[208:211], v[52:55], v[80:83]
    s_add_u32 m0, s29, 69632
    s_add_u32 s39, s54, 20480
    v_mfma_f32_16x16x32_bf16 v[84:87], a[212:215], v[52:55], v[84:87]
    buffer_load_dwordx4 v2, s[16:19], s39 offen offset:0 nt lds
    v_mfma_f32_16x16x32_bf16 v[88:91], a[216:219], v[52:55], v[88:91]
    v_add_f32 v38, v38, v20
    v_add_f32 v39, v39, v20
    v_mfma_f32_16x16x32_bf16 v[92:95], a[220:223], v[52:55], v[92:95]
    v_exp_f32 v38, v38
    v_exp_f32 v39, v39
    v_mfma_f32_16x16x32_bf16 a[224:227], a[248:251], v[52:55], a[224:227]
    v_cvt_pk_bf16_f32 v51, v38, v39
    s_waitcnt lgkmcnt(0)
    v_lshlrev_b32 v248, 16, v232
    v_and_b32 v249, 0xffff0000, v232
    v_pk_mul_f32 v[248:249], v[248:249], s[38:39] op_sel_hi:[1,0]
    v_cvt_pk_bf16_f32 v232, v248, v249
    v_accvgpr_write_b32 a32, v232
    v_lshlrev_b32 v250, 16, v233
    v_and_b32 v251, 0xffff0000, v233
    v_pk_mul_f32 v[250:251], v[250:251], s[38:39] op_sel_hi:[1,0]
    v_cvt_pk_bf16_f32 v233, v250, v251
    v_accvgpr_write_b32 a33, v233
    v_lshlrev_b32 v248, 16, v234
    v_and_b32 v249, 0xffff0000, v234
    v_pk_mul_f32 v[248:249], v[248:249], s[38:39] op_sel_hi:[1,0]
    v_cvt_pk_bf16_f32 v234, v248, v249
    v_accvgpr_write_b32 a34, v234
    v_lshlrev_b32 v250, 16, v235
    v_and_b32 v251, 0xffff0000, v235
    v_pk_mul_f32 v[250:251], v[250:251], s[38:39] op_sel_hi:[1,0]
    v_cvt_pk_bf16_f32 v235, v250, v251
    v_accvgpr_write_b32 a35, v235
    v_lshlrev_b32 v248, 16, v236
    v_and_b32 v249, 0xffff0000, v236
    v_pk_mul_f32 v[248:249], v[248:249], s[38:39] op_sel_hi:[1,0]
    v_cvt_pk_bf16_f32 v236, v248, v249
    v_accvgpr_write_b32 a36, v236
    v_lshlrev_b32 v250, 16, v237
    v_and_b32 v251, 0xffff0000, v237
    v_pk_mul_f32 v[250:251], v[250:251], s[38:39] op_sel_hi:[1,0]
    v_cvt_pk_bf16_f32 v237, v250, v251
    v_accvgpr_write_b32 a37, v237
    v_lshlrev_b32 v248, 16, v238
    v_and_b32 v249, 0xffff0000, v238
    v_pk_mul_f32 v[248:249], v[248:249], s[38:39] op_sel_hi:[1,0]
    v_cvt_pk_bf16_f32 v238, v248, v249
    v_accvgpr_write_b32 a38, v238
    v_lshlrev_b32 v250, 16, v239
    v_and_b32 v251, 0xffff0000, v239
    v_pk_mul_f32 v[250:251], v[250:251], s[38:39] op_sel_hi:[1,0]
    v_cvt_pk_bf16_f32 v239, v250, v251
    v_accvgpr_write_b32 a39, v239
    v_lshlrev_b32 v248, 16, v240
    v_and_b32 v249, 0xffff0000, v240
    v_pk_mul_f32 v[248:249], v[248:249], s[38:39] op_sel_hi:[1,0]
    v_cvt_pk_bf16_f32 v240, v248, v249
    v_accvgpr_write_b32 a40, v240
    v_lshlrev_b32 v250, 16, v241
    v_and_b32 v251, 0xffff0000, v241
    v_pk_mul_f32 v[250:251], v[250:251], s[38:39] op_sel_hi:[1,0]
    v_cvt_pk_bf16_f32 v241, v250, v251
    v_accvgpr_write_b32 a41, v241
    v_lshlrev_b32 v248, 16, v242
    v_and_b32 v249, 0xffff0000, v242
    v_pk_mul_f32 v[248:249], v[248:249], s[38:39] op_sel_hi:[1,0]
    v_cvt_pk_bf16_f32 v242, v248, v249
    v_accvgpr_write_b32 a42, v242
    v_lshlrev_b32 v250, 16, v243
    v_and_b32 v251, 0xffff0000, v243
    v_pk_mul_f32 v[250:251], v[250:251], s[38:39] op_sel_hi:[1,0]
    v_cvt_pk_bf16_f32 v243, v250, v251
    v_accvgpr_write_b32 a43, v243
    v_lshlrev_b32 v248, 16, v244
    v_and_b32 v249, 0xffff0000, v244
    v_pk_mul_f32 v[248:249], v[248:249], s[38:39] op_sel_hi:[1,0]
    v_cvt_pk_bf16_f32 v244, v248, v249
    v_accvgpr_write_b32 a44, v244
    v_lshlrev_b32 v250, 16, v245
    v_and_b32 v251, 0xffff0000, v245
    v_pk_mul_f32 v[250:251], v[250:251], s[38:39] op_sel_hi:[1,0]
    v_cvt_pk_bf16_f32 v245, v250, v251
    v_accvgpr_write_b32 a45, v245
    v_lshlrev_b32 v248, 16, v246
    v_and_b32 v249, 0xffff0000, v246
    v_pk_mul_f32 v[248:249], v[248:249], s[38:39] op_sel_hi:[1,0]
    v_cvt_pk_bf16_f32 v246, v248, v249
    v_accvgpr_write_b32 a46, v246
    v_lshlrev_b32 v250, 16, v247
    v_and_b32 v251, 0xffff0000, v247
    v_pk_mul_f32 v[250:251], v[250:251], s[38:39] op_sel_hi:[1,0]
    v_cvt_pk_bf16_f32 v247, v250, v251
    v_accvgpr_write_b32 a47, v247
    v_mfma_f32_16x16x32_bf16 v[32:35], a[96:99], a[32:35], 0
    buffer_load_dwordx4 v3, s[16:19], s39 offen offset:1024 nt lds
    v_mfma_f32_16x16x32_bf16 v[32:35], a[100:103], a[36:39], v[32:35]
    v_add_f32 v40, v40, v20
    v_add_f32 v41, v41, v20
    v_mfma_f32_16x16x32_bf16 v[32:35], a[104:107], a[40:43], v[32:35]
    v_exp_f32 v40, v40
    v_mfma_f32_16x16x32_bf16 v[32:35], a[108:111], a[44:47], v[32:35]
    v_exp_f32 v41, v41
    v_mfma_f32_16x16x32_bf16 v[36:39], a[112:115], a[32:35], 0
    buffer_load_dwordx4 v2, s[16:19], s39 offen offset:2048 nt lds
    v_cvt_pk_bf16_f32 v52, v40, v41
    v_mfma_f32_16x16x32_bf16 v[36:39], a[116:119], a[36:39], v[36:39]
    v_add_f32 v42, v42, v20
    v_add_f32 v43, v43, v20
    v_mfma_f32_16x16x32_bf16 v[36:39], a[120:123], a[40:43], v[36:39]
    v_exp_f32 v42, v42
    v_mfma_f32_16x16x32_bf16 v[36:39], a[124:127], a[44:47], v[36:39]
    v_exp_f32 v43, v43
    v_mfma_f32_16x16x32_bf16 v[96:99], a[160:163], v[48:51], 0
    buffer_load_dwordx4 v3, s[16:19], s39 offen offset:3072 nt lds
    v_mfma_f32_16x16x32_bf16 v[100:103], a[164:167], v[48:51], 0
    v_cvt_pk_bf16_f32 v53, v42, v43
    v_add_f32 v44, v44, v20
    v_mfma_f32_16x16x32_bf16 v[104:107], a[168:171], v[48:51], 0
    v_exp_f32 v44, v44
    v_mfma_f32_16x16x32_bf16 v[108:111], a[172:175], v[48:51], 0
    v_max3_f32 v228, v32, v33, v34
    v_max3_f32 v228, v228, v35, v36
    v_add_f32 v45, v45, v20
    v_mfma_f32_16x16x32_bf16 v[112:115], a[176:179], v[48:51], 0
    v_max3_f32 v228, v228, v37, v38
    v_max_f32 v228, v228, v39
    v_exp_f32 v45, v45
    v_mfma_f32_16x16x32_bf16 v[116:119], a[180:183], v[48:51], 0
    v_mov_b32 v229, v228
    v_cvt_pk_bf16_f32 v54, v44, v45
    v_mfma_f32_16x16x32_bf16 v[120:123], a[184:187], v[48:51], 0
    v_permlane32_swap_b32 v228, v229
    v_max_f32 v228, v228, v229
    v_mov_b32 v229, v228
    v_mfma_f32_16x16x32_bf16 v[124:127], a[188:191], v[48:51], 0
    s_nop 0
    v_permlane16_swap_b32 v228, v229
    v_max_f32 v228, v228, v229
    v_mfma_f32_16x16x32_bf16 a[228:231], a[248:251], v[48:51], 0
    v_mul_f32 v56, -1.0, v228
    v_mul_f32 v57, -1.0, v228
    v_mul_f32 v58, -1.0, v228
    v_mul_f32 v59, -1.0, v228
    v_mfma_f32_16x16x32_bf16 v[40:43], a[128:131], a[32:35], 0
    v_add_f32 v46, v46, v20
    v_add_f32 v47, v47, v20
    v_mfma_f32_16x16x32_bf16 v[40:43], a[132:135], a[36:39], v[40:43]
    v_exp_f32 v46, v46
    v_mfma_f32_16x16x32_bf16 v[40:43], a[136:139], a[40:43], v[40:43]
    v_exp_f32 v47, v47
    v_mfma_f32_16x16x32_bf16 v[40:43], a[140:143], a[44:47], v[40:43]
    v_cvt_pk_bf16_f32 v55, v46, v47
    v_add_f32 v32, v32, v56
    v_mfma_f32_16x16x32_bf16 v[44:47], a[144:147], a[32:35], 0
    v_add_f32 v33, v33, v56
    v_exp_f32 v32, v32
    v_mfma_f32_16x16x32_bf16 v[44:47], a[148:151], a[36:39], v[44:47]
    v_exp_f32 v33, v33
    v_mfma_f32_16x16x32_bf16 v[44:47], a[152:155], a[40:43], v[44:47]
    v_cvt_pk_bf16_f32 v48, v32, v33
    v_add_f32 v34, v34, v56
    v_mfma_f32_16x16x32_bf16 v[44:47], a[156:159], a[44:47], v[44:47]
    v_add_f32 v35, v35, v56
    v_exp_f32 v34, v34
    v_mfma_f32_16x16x32_bf16 v[96:99], a[192:195], v[52:55], v[96:99]
    v_exp_f32 v35, v35
    v_mfma_f32_16x16x32_bf16 v[100:103], a[196:199], v[52:55], v[100:103]
    v_cvt_pk_bf16_f32 v49, v34, v35
    v_add_f32 v36, v36, v56
    v_mfma_f32_16x16x32_bf16 v[104:107], a[200:203], v[52:55], v[104:107]
    v_add_f32 v37, v37, v56
    v_exp_f32 v36, v36
    v_mfma_f32_16x16x32_bf16 v[108:111], a[204:207], v[52:55], v[108:111]
    s_waitcnt vmcnt(12)
    ds_read_b128 v[232:235], v224 offset:12288
    ds_read_b128 v[236:239], v225 offset:12288
    ds_read_b128 v[240:243], v226 offset:12288
    ds_read_b128 v[244:247], v227 offset:12288
    v_exp_f32 v37, v37
    v_mfma_f32_16x16x32_bf16 v[112:115], a[208:211], v[52:55], v[112:115]
    s_add_u32 m0, s29, 36864
    v_cvt_pk_bf16_f32 v50, v36, v37
    v_mfma_f32_16x16x32_bf16 v[116:119], a[212:215], v[52:55], v[116:119]
    buffer_load_dwordx4 v2, s[8:11], s30 offen offset:0 nt lds
    v_mfma_f32_16x16x32_bf16 v[120:123], a[216:219], v[52:55], v[120:123]
    v_add_f32 v38, v38, v56
    v_add_f32 v39, v39, v56
    v_mfma_f32_16x16x32_bf16 v[124:127], a[220:223], v[52:55], v[124:127]
    v_exp_f32 v38, v38
    v_exp_f32 v39, v39
    v_mfma_f32_16x16x32_bf16 a[228:231], a[248:251], v[52:55], a[228:231]
    v_cvt_pk_bf16_f32 v51, v38, v39
    s_waitcnt lgkmcnt(0)
    v_lshlrev_b32 v248, 16, v232
    v_and_b32 v249, 0xffff0000, v232
    v_pk_mul_f32 v[248:249], v[248:249], s[38:39] op_sel_hi:[1,0]
    v_cvt_pk_bf16_f32 v232, v248, v249
    v_accvgpr_write_b32 a48, v232
    v_lshlrev_b32 v250, 16, v233
    v_and_b32 v251, 0xffff0000, v233
    v_pk_mul_f32 v[250:251], v[250:251], s[38:39] op_sel_hi:[1,0]
    v_cvt_pk_bf16_f32 v233, v250, v251
    v_accvgpr_write_b32 a49, v233
    v_lshlrev_b32 v248, 16, v234
    v_and_b32 v249, 0xffff0000, v234
    v_pk_mul_f32 v[248:249], v[248:249], s[38:39] op_sel_hi:[1,0]
    v_cvt_pk_bf16_f32 v234, v248, v249
    v_accvgpr_write_b32 a50, v234
    v_lshlrev_b32 v250, 16, v235
    v_and_b32 v251, 0xffff0000, v235
    v_pk_mul_f32 v[250:251], v[250:251], s[38:39] op_sel_hi:[1,0]
    v_cvt_pk_bf16_f32 v235, v250, v251
    v_accvgpr_write_b32 a51, v235
    v_lshlrev_b32 v248, 16, v236
    v_and_b32 v249, 0xffff0000, v236
    v_pk_mul_f32 v[248:249], v[248:249], s[38:39] op_sel_hi:[1,0]
    v_cvt_pk_bf16_f32 v236, v248, v249
    v_accvgpr_write_b32 a52, v236
    v_lshlrev_b32 v250, 16, v237
    v_and_b32 v251, 0xffff0000, v237
    v_pk_mul_f32 v[250:251], v[250:251], s[38:39] op_sel_hi:[1,0]
    v_cvt_pk_bf16_f32 v237, v250, v251
    v_accvgpr_write_b32 a53, v237
    v_lshlrev_b32 v248, 16, v238
    v_and_b32 v249, 0xffff0000, v238
    v_pk_mul_f32 v[248:249], v[248:249], s[38:39] op_sel_hi:[1,0]
    v_cvt_pk_bf16_f32 v238, v248, v249
    v_accvgpr_write_b32 a54, v238
    v_lshlrev_b32 v250, 16, v239
    v_and_b32 v251, 0xffff0000, v239
    v_pk_mul_f32 v[250:251], v[250:251], s[38:39] op_sel_hi:[1,0]
    v_cvt_pk_bf16_f32 v239, v250, v251
    v_accvgpr_write_b32 a55, v239
    v_lshlrev_b32 v248, 16, v240
    v_and_b32 v249, 0xffff0000, v240
    v_pk_mul_f32 v[248:249], v[248:249], s[38:39] op_sel_hi:[1,0]
    v_cvt_pk_bf16_f32 v240, v248, v249
    v_accvgpr_write_b32 a56, v240
    v_lshlrev_b32 v250, 16, v241
    v_and_b32 v251, 0xffff0000, v241
    v_pk_mul_f32 v[250:251], v[250:251], s[38:39] op_sel_hi:[1,0]
    v_cvt_pk_bf16_f32 v241, v250, v251
    v_accvgpr_write_b32 a57, v241
    v_lshlrev_b32 v248, 16, v242
    v_and_b32 v249, 0xffff0000, v242
    v_pk_mul_f32 v[248:249], v[248:249], s[38:39] op_sel_hi:[1,0]
    v_cvt_pk_bf16_f32 v242, v248, v249
    v_accvgpr_write_b32 a58, v242
    v_lshlrev_b32 v250, 16, v243
    v_and_b32 v251, 0xffff0000, v243
    v_pk_mul_f32 v[250:251], v[250:251], s[38:39] op_sel_hi:[1,0]
    v_cvt_pk_bf16_f32 v243, v250, v251
    v_accvgpr_write_b32 a59, v243
    v_lshlrev_b32 v248, 16, v244
    v_and_b32 v249, 0xffff0000, v244
    v_pk_mul_f32 v[248:249], v[248:249], s[38:39] op_sel_hi:[1,0]
    v_cvt_pk_bf16_f32 v244, v248, v249
    v_accvgpr_write_b32 a60, v244
    v_lshlrev_b32 v250, 16, v245
    v_and_b32 v251, 0xffff0000, v245
    v_pk_mul_f32 v[250:251], v[250:251], s[38:39] op_sel_hi:[1,0]
    v_cvt_pk_bf16_f32 v245, v250, v251
    v_accvgpr_write_b32 a61, v245
    v_lshlrev_b32 v248, 16, v246
    v_and_b32 v249, 0xffff0000, v246
    v_pk_mul_f32 v[248:249], v[248:249], s[38:39] op_sel_hi:[1,0]
    v_cvt_pk_bf16_f32 v246, v248, v249
    v_accvgpr_write_b32 a62, v246
    v_lshlrev_b32 v250, 16, v247
    v_and_b32 v251, 0xffff0000, v247
    v_pk_mul_f32 v[250:251], v[250:251], s[38:39] op_sel_hi:[1,0]
    v_cvt_pk_bf16_f32 v247, v250, v251
    v_accvgpr_write_b32 a63, v247
    v_mfma_f32_16x16x32_bf16 v[32:35], a[96:99], a[48:51], 0
    buffer_load_dwordx4 v3, s[8:11], s30 offen offset:1024 nt lds
    v_mfma_f32_16x16x32_bf16 v[32:35], a[100:103], a[52:55], v[32:35]
    v_add_f32 v40, v40, v56
    v_add_f32 v41, v41, v56
    v_mfma_f32_16x16x32_bf16 v[32:35], a[104:107], a[56:59], v[32:35]
    v_exp_f32 v40, v40
    v_mfma_f32_16x16x32_bf16 v[32:35], a[108:111], a[60:63], v[32:35]
    v_exp_f32 v41, v41
    v_mfma_f32_16x16x32_bf16 v[36:39], a[112:115], a[48:51], 0
    buffer_load_dwordx4 v2, s[8:11], s30 offen offset:2048 nt lds
    v_cvt_pk_bf16_f32 v52, v40, v41
    v_mfma_f32_16x16x32_bf16 v[36:39], a[116:119], a[52:55], v[36:39]
    v_add_f32 v42, v42, v56
    v_add_f32 v43, v43, v56
    v_mfma_f32_16x16x32_bf16 v[36:39], a[120:123], a[56:59], v[36:39]
    v_exp_f32 v42, v42
    v_mfma_f32_16x16x32_bf16 v[36:39], a[124:127], a[60:63], v[36:39]
    v_exp_f32 v43, v43
    v_mfma_f32_16x16x32_bf16 v[128:131], a[160:163], v[48:51], 0
    buffer_load_dwordx4 v3, s[8:11], s30 offen offset:3072 nt lds
    v_cvt_pk_bf16_f32 v53, v42, v43
    v_mfma_f32_16x16x32_bf16 v[132:135], a[164:167], v[48:51], 0
    s_add_u32 s30, s30, 16384
    v_add_f32 v44, v44, v56
    v_mfma_f32_16x16x32_bf16 v[136:139], a[168:171], v[48:51], 0
    v_exp_f32 v44, v44
    v_mfma_f32_16x16x32_bf16 v[140:143], a[172:175], v[48:51], 0
    v_max3_f32 v228, v32, v33, v34
    v_max3_f32 v228, v228, v35, v36
    v_add_f32 v45, v45, v56
    v_mfma_f32_16x16x32_bf16 v[144:147], a[176:179], v[48:51], 0
    v_max3_f32 v228, v228, v37, v38
    v_max_f32 v228, v228, v39
    v_exp_f32 v45, v45
    v_mfma_f32_16x16x32_bf16 v[148:151], a[180:183], v[48:51], 0
    v_mov_b32 v229, v228
    v_cvt_pk_bf16_f32 v54, v44, v45
    v_mfma_f32_16x16x32_bf16 v[152:155], a[184:187], v[48:51], 0
    v_permlane32_swap_b32 v228, v229
    v_max_f32 v228, v228, v229
    v_mov_b32 v229, v228
    v_mfma_f32_16x16x32_bf16 v[156:159], a[188:191], v[48:51], 0
    s_nop 0
    v_permlane16_swap_b32 v228, v229
    v_max_f32 v228, v228, v229
    v_mfma_f32_16x16x32_bf16 a[232:235], a[248:251], v[48:51], 0
    v_mul_f32 v60, -1.0, v228
    v_mul_f32 v61, -1.0, v228
    v_mul_f32 v62, -1.0, v228
    v_mul_f32 v63, -1.0, v228
    v_mfma_f32_16x16x32_bf16 v[40:43], a[128:131], a[48:51], 0
    v_add_f32 v46, v46, v56
    v_add_f32 v47, v47, v56
    v_mfma_f32_16x16x32_bf16 v[40:43], a[132:135], a[52:55], v[40:43]
    v_exp_f32 v46, v46
    v_exp_f32 v47, v47
    v_mfma_f32_16x16x32_bf16 v[40:43], a[136:139], a[56:59], v[40:43]
    v_cvt_pk_bf16_f32 v55, v46, v47
    v_add_f32 v32, v32, v60
    v_mfma_f32_16x16x32_bf16 v[40:43], a[140:143], a[60:63], v[40:43]
    v_add_f32 v33, v33, v60
    v_exp_f32 v32, v32
    v_mfma_f32_16x16x32_bf16 v[44:47], a[144:147], a[48:51], 0
    v_exp_f32 v33, v33
    v_mfma_f32_16x16x32_bf16 v[44:47], a[148:151], a[52:55], v[44:47]
    v_cvt_pk_bf16_f32 v48, v32, v33
    v_add_f32 v34, v34, v60
    v_mfma_f32_16x16x32_bf16 v[44:47], a[152:155], a[56:59], v[44:47]
    v_add_f32 v35, v35, v60
    v_exp_f32 v34, v34
    v_mfma_f32_16x16x32_bf16 v[44:47], a[156:159], a[60:63], v[44:47]
    v_exp_f32 v35, v35
    v_mfma_f32_16x16x32_bf16 v[128:131], a[192:195], v[52:55], v[128:131]
    v_cvt_pk_bf16_f32 v49, v34, v35
    v_add_f32 v36, v36, v60
    v_mfma_f32_16x16x32_bf16 v[132:135], a[196:199], v[52:55], v[132:135]
    v_add_u32 v224, s57, v4
    v_add_u32 v225, s57, v5
    v_add_u32 v226, s57, v6
    v_add_u32 v227, s57, v7
    v_mfma_f32_16x16x32_bf16 v[136:139], a[200:203], v[52:55], v[136:139]
    v_exp_f32 v36, v36
    v_mfma_f32_16x16x32_bf16 v[140:143], a[204:207], v[52:55], v[140:143]
    s_waitcnt vmcnt(12)
    ds_read_b128 v[232:235], v224 offset:0
    ds_read_b128 v[236:239], v225 offset:0
    ds_read_b128 v[240:243], v226 offset:0
    ds_read_b128 v[244:247], v227 offset:0
    v_add_f32 v37, v37, v60
    v_mfma_f32_16x16x32_bf16 v[144:147], a[208:211], v[52:55], v[144:147]
    v_exp_f32 v37, v37
    v_mfma_f32_16x16x32_bf16 v[148:151], a[212:215], v[52:55], v[148:151]
    v_cvt_pk_bf16_f32 v50, v36, v37
    v_add_f32 v38, v38, v60
    v_mfma_f32_16x16x32_bf16 v[152:155], a[216:219], v[52:55], v[152:155]
    v_add_f32 v39, v39, v60
    v_exp_f32 v38, v38
    v_mfma_f32_16x16x32_bf16 v[156:159], a[220:223], v[52:55], v[156:159]
    v_exp_f32 v39, v39
    v_mfma_f32_16x16x32_bf16 a[232:235], a[248:251], v[52:55], a[232:235]
    v_cvt_pk_bf16_f32 v51, v38, v39
    s_waitcnt lgkmcnt(0)
    v_lshlrev_b32 v248, 16, v232
    v_and_b32 v249, 0xffff0000, v232
    v_pk_mul_f32 v[248:249], v[248:249], s[38:39] op_sel_hi:[1,0]
    v_cvt_pk_bf16_f32 v232, v248, v249
    v_accvgpr_write_b32 a64, v232
    v_lshlrev_b32 v250, 16, v233
    v_and_b32 v251, 0xffff0000, v233
    v_pk_mul_f32 v[250:251], v[250:251], s[38:39] op_sel_hi:[1,0]
    v_cvt_pk_bf16_f32 v233, v250, v251
    v_accvgpr_write_b32 a65, v233
    v_lshlrev_b32 v248, 16, v234
    v_and_b32 v249, 0xffff0000, v234
    v_pk_mul_f32 v[248:249], v[248:249], s[38:39] op_sel_hi:[1,0]
    v_cvt_pk_bf16_f32 v234, v248, v249
    v_accvgpr_write_b32 a66, v234
    v_lshlrev_b32 v250, 16, v235
    v_and_b32 v251, 0xffff0000, v235
    v_pk_mul_f32 v[250:251], v[250:251], s[38:39] op_sel_hi:[1,0]
    v_cvt_pk_bf16_f32 v235, v250, v251
    v_accvgpr_write_b32 a67, v235
    v_lshlrev_b32 v248, 16, v236
    v_and_b32 v249, 0xffff0000, v236
    v_pk_mul_f32 v[248:249], v[248:249], s[38:39] op_sel_hi:[1,0]
    v_cvt_pk_bf16_f32 v236, v248, v249
    v_accvgpr_write_b32 a68, v236
    v_lshlrev_b32 v250, 16, v237
    v_and_b32 v251, 0xffff0000, v237
    v_pk_mul_f32 v[250:251], v[250:251], s[38:39] op_sel_hi:[1,0]
    v_cvt_pk_bf16_f32 v237, v250, v251
    v_accvgpr_write_b32 a69, v237
    v_lshlrev_b32 v248, 16, v238
    v_and_b32 v249, 0xffff0000, v238
    v_pk_mul_f32 v[248:249], v[248:249], s[38:39] op_sel_hi:[1,0]
    v_cvt_pk_bf16_f32 v238, v248, v249
    v_accvgpr_write_b32 a70, v238
    v_lshlrev_b32 v250, 16, v239
    v_and_b32 v251, 0xffff0000, v239
    v_pk_mul_f32 v[250:251], v[250:251], s[38:39] op_sel_hi:[1,0]
    v_cvt_pk_bf16_f32 v239, v250, v251
    v_accvgpr_write_b32 a71, v239
    v_lshlrev_b32 v248, 16, v240
    v_and_b32 v249, 0xffff0000, v240
    v_pk_mul_f32 v[248:249], v[248:249], s[38:39] op_sel_hi:[1,0]
    v_cvt_pk_bf16_f32 v240, v248, v249
    v_accvgpr_write_b32 a72, v240
    v_lshlrev_b32 v250, 16, v241
    v_and_b32 v251, 0xffff0000, v241
    v_pk_mul_f32 v[250:251], v[250:251], s[38:39] op_sel_hi:[1,0]
    v_cvt_pk_bf16_f32 v241, v250, v251
    v_accvgpr_write_b32 a73, v241
    v_lshlrev_b32 v248, 16, v242
    v_and_b32 v249, 0xffff0000, v242
    v_pk_mul_f32 v[248:249], v[248:249], s[38:39] op_sel_hi:[1,0]
    v_cvt_pk_bf16_f32 v242, v248, v249
    v_accvgpr_write_b32 a74, v242
    v_lshlrev_b32 v250, 16, v243
    v_and_b32 v251, 0xffff0000, v243
    v_pk_mul_f32 v[250:251], v[250:251], s[38:39] op_sel_hi:[1,0]
    v_cvt_pk_bf16_f32 v243, v250, v251
    v_accvgpr_write_b32 a75, v243
    v_lshlrev_b32 v248, 16, v244
    v_and_b32 v249, 0xffff0000, v244
    v_pk_mul_f32 v[248:249], v[248:249], s[38:39] op_sel_hi:[1,0]
    v_cvt_pk_bf16_f32 v244, v248, v249
    v_accvgpr_write_b32 a76, v244
    v_lshlrev_b32 v250, 16, v245
    v_and_b32 v251, 0xffff0000, v245
    v_pk_mul_f32 v[250:251], v[250:251], s[38:39] op_sel_hi:[1,0]
    v_cvt_pk_bf16_f32 v245, v250, v251
    v_accvgpr_write_b32 a77, v245
    v_lshlrev_b32 v248, 16, v246
    v_and_b32 v249, 0xffff0000, v246
    v_pk_mul_f32 v[248:249], v[248:249], s[38:39] op_sel_hi:[1,0]
    v_cvt_pk_bf16_f32 v246, v248, v249
    v_accvgpr_write_b32 a78, v246
    v_lshlrev_b32 v250, 16, v247
    v_and_b32 v251, 0xffff0000, v247
    v_pk_mul_f32 v[250:251], v[250:251], s[38:39] op_sel_hi:[1,0]
    v_cvt_pk_bf16_f32 v247, v250, v251
    v_accvgpr_write_b32 a79, v247
    v_mfma_f32_16x16x32_bf16 v[32:35], a[96:99], a[64:67], 0
    v_add_f32 v40, v40, v60
    v_add_f32 v41, v41, v60
    v_mfma_f32_16x16x32_bf16 v[32:35], a[100:103], a[68:71], v[32:35]
    v_exp_f32 v40, v40
    v_mfma_f32_16x16x32_bf16 v[32:35], a[104:107], a[72:75], v[32:35]
    v_exp_f32 v41, v41
    v_mfma_f32_16x16x32_bf16 v[32:35], a[108:111], a[76:79], v[32:35]
    v_cvt_pk_bf16_f32 v52, v40, v41
    v_add_f32 v42, v42, v60
    v_mfma_f32_16x16x32_bf16 v[36:39], a[112:115], a[64:67], 0
    v_add_f32 v43, v43, v60
    v_exp_f32 v42, v42
    v_mfma_f32_16x16x32_bf16 v[36:39], a[116:119], a[68:71], v[36:39]
    v_exp_f32 v43, v43
    v_mfma_f32_16x16x32_bf16 v[36:39], a[120:123], a[72:75], v[36:39]
    v_cvt_pk_bf16_f32 v53, v42, v43
    v_add_f32 v44, v44, v60
    v_mfma_f32_16x16x32_bf16 v[36:39], a[124:127], a[76:79], v[36:39]
    v_add_f32 v45, v45, v60
    v_exp_f32 v44, v44
    v_mfma_f32_16x16x32_bf16 v[160:163], a[160:163], v[48:51], 0
    v_exp_f32 v45, v45
    v_mfma_f32_16x16x32_bf16 v[164:167], a[164:167], v[48:51], 0
    v_cvt_pk_bf16_f32 v54, v44, v45
    v_add_f32 v46, v46, v60
    v_mfma_f32_16x16x32_bf16 v[168:171], a[168:171], v[48:51], 0
    v_exp_f32 v46, v46
    v_mfma_f32_16x16x32_bf16 v[172:175], a[172:175], v[48:51], 0
    v_max3_f32 v228, v32, v33, v34
    v_max3_f32 v228, v228, v35, v36
    v_add_f32 v47, v47, v60
    v_mfma_f32_16x16x32_bf16 v[176:179], a[176:179], v[48:51], 0
    v_max3_f32 v228, v228, v37, v38
    v_max_f32 v228, v228, v39
    v_exp_f32 v47, v47
    v_mfma_f32_16x16x32_bf16 v[180:183], a[180:183], v[48:51], 0
    v_mov_b32 v229, v228
    v_cvt_pk_bf16_f32 v55, v46, v47
    v_mfma_f32_16x16x32_bf16 v[184:187], a[184:187], v[48:51], 0
    v_permlane32_swap_b32 v228, v229
    v_max_f32 v228, v228, v229
    v_mov_b32 v229, v228
    v_mfma_f32_16x16x32_bf16 v[188:191], a[188:191], v[48:51], 0
    s_nop 0
    v_permlane16_swap_b32 v228, v229
    v_max_f32 v228, v228, v229
    v_mfma_f32_16x16x32_bf16 a[236:239], a[248:251], v[48:51], 0
    v_mul_f32 v24, -1.0, v228
    v_mul_f32 v25, -1.0, v228
    v_mul_f32 v26, -1.0, v228
    v_mul_f32 v27, -1.0, v228
    v_mfma_f32_16x16x32_bf16 v[40:43], a[128:131], a[64:67], 0
    v_add_f32 v32, v32, v24
    v_add_f32 v33, v33, v24
    v_mfma_f32_16x16x32_bf16 v[40:43], a[132:135], a[68:71], v[40:43]
    v_exp_f32 v32, v32
    v_exp_f32 v33, v33
    v_mfma_f32_16x16x32_bf16 v[40:43], a[136:139], a[72:75], v[40:43]
    v_cvt_pk_bf16_f32 v48, v32, v33
    v_add_f32 v34, v34, v24
    v_mfma_f32_16x16x32_bf16 v[40:43], a[140:143], a[76:79], v[40:43]
    v_add_f32 v35, v35, v24
    v_exp_f32 v34, v34
    v_mfma_f32_16x16x32_bf16 v[44:47], a[144:147], a[64:67], 0
    v_exp_f32 v35, v35
    v_mfma_f32_16x16x32_bf16 v[44:47], a[148:151], a[68:71], v[44:47]
    v_cvt_pk_bf16_f32 v49, v34, v35
    v_add_f32 v36, v36, v24
    v_mfma_f32_16x16x32_bf16 v[44:47], a[152:155], a[72:75], v[44:47]
    v_add_f32 v37, v37, v24
    v_exp_f32 v36, v36
    v_mfma_f32_16x16x32_bf16 v[44:47], a[156:159], a[76:79], v[44:47]
    v_exp_f32 v37, v37
    v_mfma_f32_16x16x32_bf16 v[160:163], a[192:195], v[52:55], v[160:163]
    v_cvt_pk_bf16_f32 v50, v36, v37
    v_add_f32 v38, v38, v24
    v_mfma_f32_16x16x32_bf16 v[164:167], a[196:199], v[52:55], v[164:167]
    v_add_f32 v39, v39, v24
    v_exp_f32 v38, v38
    v_mfma_f32_16x16x32_bf16 v[168:171], a[200:203], v[52:55], v[168:171]
    v_exp_f32 v39, v39
    v_mfma_f32_16x16x32_bf16 v[172:175], a[204:207], v[52:55], v[172:175]
    s_waitcnt vmcnt(4)
    s_barrier
    ds_read_b128 v[232:235], v224 offset:4096
    ds_read_b128 v[236:239], v225 offset:4096
    ds_read_b128 v[240:243], v226 offset:4096
    ds_read_b128 v[244:247], v227 offset:4096
    v_cvt_pk_bf16_f32 v51, v38, v39
    v_mfma_f32_16x16x32_bf16 v[176:179], a[208:211], v[52:55], v[176:179]
    v_add_u32 v4, 32768, v4
    v_add_u32 v5, 32768, v5
    v_add_u32 v6, 32768, v6
    v_add_u32 v7, 32768, v7
    v_mfma_f32_16x16x32_bf16 v[180:183], a[212:215], v[52:55], v[180:183]
    v_add_u32 v8, 32768, v8
    v_add_u32 v9, 32768, v9
    v_add_u32 v10, 32768, v10
    v_add_u32 v11, 32768, v11
    v_add_u32 v12, 32768, v12
    v_add_u32 v13, 32768, v13
    v_add_u32 v14, 32768, v14
    v_add_u32 v15, 32768, v15
    v_mfma_f32_16x16x32_bf16 v[184:187], a[216:219], v[52:55], v[184:187]
    v_add_f32 v40, v40, v24
    v_add_f32 v41, v41, v24
    v_mfma_f32_16x16x32_bf16 v[188:191], a[220:223], v[52:55], v[188:191]
    v_exp_f32 v40, v40
    v_mfma_f32_16x16x32_bf16 a[236:239], a[248:251], v[52:55], a[236:239]
    v_exp_f32 v41, v41
    s_waitcnt lgkmcnt(0)
    v_lshlrev_b32 v248, 16, v232
    v_and_b32 v249, 0xffff0000, v232
    v_pk_mul_f32 v[248:249], v[248:249], s[38:39] op_sel_hi:[1,0]
    v_cvt_pk_bf16_f32 v232, v248, v249
    v_accvgpr_write_b32 a80, v232
    v_lshlrev_b32 v250, 16, v233
    v_and_b32 v251, 0xffff0000, v233
    v_pk_mul_f32 v[250:251], v[250:251], s[38:39] op_sel_hi:[1,0]
    v_cvt_pk_bf16_f32 v233, v250, v251
    v_accvgpr_write_b32 a81, v233
    v_lshlrev_b32 v248, 16, v234
    v_and_b32 v249, 0xffff0000, v234
    v_pk_mul_f32 v[248:249], v[248:249], s[38:39] op_sel_hi:[1,0]
    v_cvt_pk_bf16_f32 v234, v248, v249
    v_accvgpr_write_b32 a82, v234
    v_lshlrev_b32 v250, 16, v235
    v_and_b32 v251, 0xffff0000, v235
    v_pk_mul_f32 v[250:251], v[250:251], s[38:39] op_sel_hi:[1,0]
    v_cvt_pk_bf16_f32 v235, v250, v251
    v_accvgpr_write_b32 a83, v235
    v_lshlrev_b32 v248, 16, v236
    v_and_b32 v249, 0xffff0000, v236
    v_pk_mul_f32 v[248:249], v[248:249], s[38:39] op_sel_hi:[1,0]
    v_cvt_pk_bf16_f32 v236, v248, v249
    v_accvgpr_write_b32 a84, v236
    v_lshlrev_b32 v250, 16, v237
    v_and_b32 v251, 0xffff0000, v237
    v_pk_mul_f32 v[250:251], v[250:251], s[38:39] op_sel_hi:[1,0]
    v_cvt_pk_bf16_f32 v237, v250, v251
    v_accvgpr_write_b32 a85, v237
    v_lshlrev_b32 v248, 16, v238
    v_and_b32 v249, 0xffff0000, v238
    v_pk_mul_f32 v[248:249], v[248:249], s[38:39] op_sel_hi:[1,0]
    v_cvt_pk_bf16_f32 v238, v248, v249
    v_accvgpr_write_b32 a86, v238
    v_lshlrev_b32 v250, 16, v239
    v_and_b32 v251, 0xffff0000, v239
    v_pk_mul_f32 v[250:251], v[250:251], s[38:39] op_sel_hi:[1,0]
    v_cvt_pk_bf16_f32 v239, v250, v251
    v_accvgpr_write_b32 a87, v239
    v_lshlrev_b32 v248, 16, v240
    v_and_b32 v249, 0xffff0000, v240
    v_pk_mul_f32 v[248:249], v[248:249], s[38:39] op_sel_hi:[1,0]
    v_cvt_pk_bf16_f32 v240, v248, v249
    v_accvgpr_write_b32 a88, v240
    v_lshlrev_b32 v250, 16, v241
    v_and_b32 v251, 0xffff0000, v241
    v_pk_mul_f32 v[250:251], v[250:251], s[38:39] op_sel_hi:[1,0]
    v_cvt_pk_bf16_f32 v241, v250, v251
    v_accvgpr_write_b32 a89, v241
    v_lshlrev_b32 v248, 16, v242
    v_and_b32 v249, 0xffff0000, v242
    v_pk_mul_f32 v[248:249], v[248:249], s[38:39] op_sel_hi:[1,0]
    v_cvt_pk_bf16_f32 v242, v248, v249
    v_accvgpr_write_b32 a90, v242
    v_lshlrev_b32 v250, 16, v243
    v_and_b32 v251, 0xffff0000, v243
    v_pk_mul_f32 v[250:251], v[250:251], s[38:39] op_sel_hi:[1,0]
    v_cvt_pk_bf16_f32 v243, v250, v251
    v_accvgpr_write_b32 a91, v243
    v_lshlrev_b32 v248, 16, v244
    v_and_b32 v249, 0xffff0000, v244
    v_pk_mul_f32 v[248:249], v[248:249], s[38:39] op_sel_hi:[1,0]
    v_cvt_pk_bf16_f32 v244, v248, v249
    v_accvgpr_write_b32 a92, v244
    v_lshlrev_b32 v250, 16, v245
    v_and_b32 v251, 0xffff0000, v245
    v_pk_mul_f32 v[250:251], v[250:251], s[38:39] op_sel_hi:[1,0]
    v_cvt_pk_bf16_f32 v245, v250, v251
    v_accvgpr_write_b32 a93, v245
    v_lshlrev_b32 v248, 16, v246
    v_and_b32 v249, 0xffff0000, v246
    v_pk_mul_f32 v[248:249], v[248:249], s[38:39] op_sel_hi:[1,0]
    v_cvt_pk_bf16_f32 v246, v248, v249
    v_accvgpr_write_b32 a94, v246
    v_lshlrev_b32 v250, 16, v247
    v_and_b32 v251, 0xffff0000, v247
    v_pk_mul_f32 v[250:251], v[250:251], s[38:39] op_sel_hi:[1,0]
    v_cvt_pk_bf16_f32 v247, v250, v251
    v_accvgpr_write_b32 a95, v247
    v_mfma_f32_16x16x32_bf16 v[32:35], a[96:99], a[80:83], 0
    s_mov_b32 m0, s57
    v_cvt_pk_bf16_f32 v52, v40, v41
    v_mfma_f32_16x16x32_bf16 v[32:35], a[100:103], a[84:87], v[32:35]
    buffer_load_dwordx4 v2, s[4:7], s30 offen offset:0 nt lds
    v_mfma_f32_16x16x32_bf16 v[32:35], a[104:107], a[88:91], v[32:35]
    v_add_f32 v42, v42, v24
    v_add_f32 v43, v43, v24
    v_mfma_f32_16x16x32_bf16 v[32:35], a[108:111], a[92:95], v[32:35]
    v_exp_f32 v42, v42
    v_mfma_f32_16x16x32_bf16 v[36:39], a[112:115], a[80:83], 0
    v_exp_f32 v43, v43
    v_mfma_f32_16x16x32_bf16 v[36:39], a[116:119], a[84:87], v[36:39]
    buffer_load_dwordx4 v3, s[4:7], s30 offen offset:1024 nt lds
    v_cvt_pk_bf16_f32 v53, v42, v43
    v_mfma_f32_16x16x32_bf16 v[36:39], a[120:123], a[88:91], v[36:39]
    v_add_f32 v44, v44, v24
    v_add_f32 v45, v45, v24
    v_mfma_f32_16x16x32_bf16 v[36:39], a[124:127], a[92:95], v[36:39]
    v_exp_f32 v44, v44
    v_exp_f32 v45, v45
    v_mfma_f32_16x16x32_bf16 v[192:195], a[160:163], v[48:51], 0
    buffer_load_dwordx4 v2, s[4:7], s30 offen offset:2048 nt lds
    v_cvt_pk_bf16_f32 v54, v44, v45
    v_mfma_f32_16x16x32_bf16 v[196:199], a[164:167], v[48:51], 0
    ds_read_b128 a[96:99], v4 offset:0
    v_add_f32 v46, v46, v24
    v_add_f32 v47, v47, v24
    v_mfma_f32_16x16x32_bf16 v[200:203], a[168:171], v[48:51], 0
    ds_read_b128 a[100:103], v5 offset:0
    v_exp_f32 v46, v46
    v_exp_f32 v47, v47
    v_mfma_f32_16x16x32_bf16 v[204:207], a[172:175], v[48:51], 0
    ds_read_b128 a[104:107], v6 offset:0
    v_max3_f32 v228, v32, v33, v34
    v_max3_f32 v228, v228, v35, v36
    v_cvt_pk_bf16_f32 v55, v46, v47
    v_mfma_f32_16x16x32_bf16 v[208:211], a[176:179], v[48:51], 0
    ds_read_b128 a[108:111], v7 offset:0
    v_max3_f32 v228, v228, v37, v38
    v_max_f32 v228, v228, v39
    v_mfma_f32_16x16x32_bf16 v[212:215], a[180:183], v[48:51], 0
    ds_read_b128 a[112:115], v4 offset:8192
    v_mov_b32 v229, v228
    v_mfma_f32_16x16x32_bf16 v[216:219], a[184:187], v[48:51], 0
    ds_read_b128 a[116:119], v5 offset:8192
    v_permlane32_swap_b32 v228, v229
    v_max_f32 v228, v228, v229
    v_mov_b32 v229, v228
    v_mfma_f32_16x16x32_bf16 v[220:223], a[188:191], v[48:51], 0
    ds_read_b128 a[120:123], v6 offset:8192
    v_permlane16_swap_b32 v228, v229
    v_max_f32 v228, v228, v229
    v_mfma_f32_16x16x32_bf16 a[240:243], a[248:251], v[48:51], 0
    ds_read_b128 a[124:127], v7 offset:8192
    v_mul_f32 v28, -1.0, v228
    v_mul_f32 v29, -1.0, v228
    v_mul_f32 v30, -1.0, v228
    v_mul_f32 v31, -1.0, v228
    v_mfma_f32_16x16x32_bf16 v[40:43], a[128:131], a[80:83], 0
    buffer_load_dwordx4 v3, s[4:7], s30 offen offset:3072 nt lds
    v_mfma_f32_16x16x32_bf16 v[40:43], a[132:135], a[84:87], v[40:43]
    s_add_u32 m0, m0, 4096
    v_add_f32 v32, v32, v28
    v_mfma_f32_16x16x32_bf16 v[40:43], a[136:139], a[88:91], v[40:43]
    v_add_f32 v33, v33, v28
    v_exp_f32 v32, v32
    v_mfma_f32_16x16x32_bf16 v[40:43], a[140:143], a[92:95], v[40:43]
    v_exp_f32 v33, v33
    v_mfma_f32_16x16x32_bf16 v[44:47], a[144:147], a[80:83], 0
    buffer_load_dwordx4 v2, s[8:11], s30 offen offset:0 nt lds
    v_cvt_pk_bf16_f32 v48, v32, v33
    v_mfma_f32_16x16x32_bf16 v[44:47], a[148:151], a[84:87], v[44:47]
    v_add_f32 v34, v34, v28
    v_add_f32 v35, v35, v28
    v_mfma_f32_16x16x32_bf16 v[44:47], a[152:155], a[88:91], v[44:47]
    v_exp_f32 v34, v34
    v_mfma_f32_16x16x32_bf16 v[44:47], a[156:159], a[92:95], v[44:47]
    v_exp_f32 v35, v35
    v_mfma_f32_16x16x32_bf16 v[192:195], a[192:195], v[52:55], v[192:195]
    buffer_load_dwordx4 v3, s[8:11], s30 offen offset:1024 nt lds
    v_cvt_pk_bf16_f32 v49, v34, v35
    v_mfma_f32_16x16x32_bf16 v[196:199], a[196:199], v[52:55], v[196:199]
    v_add_f32 v36, v36, v28
    v_add_f32 v37, v37, v28
    v_mfma_f32_16x16x32_bf16 v[200:203], a[200:203], v[52:55], v[200:203]
    v_exp_f32 v36, v36
    v_mfma_f32_16x16x32_bf16 v[204:207], a[204:207], v[52:55], v[204:207]
    v_exp_f32 v37, v37
    v_mfma_f32_16x16x32_bf16 v[208:211], a[208:211], v[52:55], v[208:211]
    buffer_load_dwordx4 v2, s[8:11], s30 offen offset:2048 nt lds
    v_cvt_pk_bf16_f32 v50, v36, v37
    v_mfma_f32_16x16x32_bf16 v[212:215], a[212:215], v[52:55], v[212:215]
    v_add_f32 v38, v38, v28
    v_add_f32 v39, v39, v28
    v_mfma_f32_16x16x32_bf16 v[216:219], a[216:219], v[52:55], v[216:219]
    v_exp_f32 v38, v38
    v_exp_f32 v39, v39
    v_mfma_f32_16x16x32_bf16 v[220:223], a[220:223], v[52:55], v[220:223]
    v_cvt_pk_bf16_f32 v51, v38, v39
    v_add_f32 v40, v40, v28
    v_mfma_f32_16x16x32_bf16 a[240:243], a[248:251], v[52:55], a[240:243]
    buffer_load_dwordx4 v3, s[8:11], s30 offen offset:3072 nt lds
    v_mfma_f32_16x16x32_bf16 v[224:227], a[160:163], v[48:51], 0
    s_add_u32 s30, s30, 16384
    s_mov_b32 m0, s95
    v_mfma_f32_16x16x32_bf16 v[228:231], a[164:167], v[48:51], 0
    v_add_f32 v41, v41, v28
    v_exp_f32 v40, v40
    v_mfma_f32_16x16x32_bf16 v[232:235], a[168:171], v[48:51], 0
    v_exp_f32 v41, v41
    v_mfma_f32_16x16x32_bf16 v[236:239], a[172:175], v[48:51], 0
    buffer_load_dwordx4 v2, s[84:87], m0 offen offset:0 nt lds
    v_cvt_pk_bf16_f32 v52, v40, v41
    v_mfma_f32_16x16x32_bf16 v[240:243], a[176:179], v[48:51], 0
    v_add_f32 v42, v42, v28
    v_add_f32 v43, v43, v28
    v_mfma_f32_16x16x32_bf16 v[244:247], a[180:183], v[48:51], 0
    v_exp_f32 v42, v42
    v_mfma_f32_16x16x32_bf16 v[248:251], a[184:187], v[48:51], 0
    v_exp_f32 v43, v43
    v_mfma_f32_16x16x32_bf16 v[252:255], a[188:191], v[48:51], 0
    buffer_load_dwordx4 v3, s[84:87], m0 offen offset:1024 nt lds
    v_cvt_pk_bf16_f32 v53, v42, v43
    v_mfma_f32_16x16x32_bf16 a[244:247], a[248:251], v[48:51], 0
    s_mov_b32 m0, s29
    s_waitcnt lgkmcnt(0)
    v_mfma_f32_16x16x32_bf16 v[32:35], a[96:99], a[0:3], v[16:19]
    s_waitcnt vmcnt(10)
    s_barrier
    v_mfma_f32_16x16x32_bf16 v[32:35], a[100:103], a[4:7], v[32:35]
    ds_read_b64_tr_b16 a[160:161], v8 offset:0
    v_add_f32 v44, v44, v28
    v_mfma_f32_16x16x32_bf16 v[32:35], a[104:107], a[8:11], v[32:35]
    ds_read_b64_tr_b16 a[162:163], v8 offset:8192
    v_add_f32 v45, v45, v28
    v_mfma_f32_16x16x32_bf16 v[32:35], a[108:111], a[12:15], v[32:35]
    ds_read_b64_tr_b16 a[164:165], v9 offset:0
    v_exp_f32 v44, v44
    v_exp_f32 v45, v45
    v_mfma_f32_16x16x32_bf16 v[36:39], a[112:115], a[0:3], v[16:19]
    ds_read_b64_tr_b16 a[166:167], v9 offset:8192
    v_cvt_pk_bf16_f32 v54, v44, v45
    v_mfma_f32_16x16x32_bf16 v[36:39], a[116:119], a[4:7], v[36:39]
    buffer_load_dwordx4 v2, s[4:7], s30 offen offset:0 nt lds
    v_mfma_f32_16x16x32_bf16 v[36:39], a[120:123], a[8:11], v[36:39]
    ds_read_b64_tr_b16 a[168:169], v10 offset:0
    v_add_f32 v46, v46, v28
    v_mfma_f32_16x16x32_bf16 v[36:39], a[124:127], a[12:15], v[36:39]
    ds_read_b64_tr_b16 a[170:171], v10 offset:8192
    v_add_f32 v47, v47, v28
    v_mfma_f32_16x16x32_bf16 v[40:43], a[96:99], a[16:19], v[20:23]
    ds_read_b64_tr_b16 a[172:173], v11 offset:0
    v_exp_f32 v46, v46
    v_exp_f32 v47, v47
    v_mfma_f32_16x16x32_bf16 v[40:43], a[100:103], a[20:23], v[40:43]
    ds_read_b64_tr_b16 a[174:175], v11 offset:8192
    v_cvt_pk_bf16_f32 v55, v46, v47
    v_mfma_f32_16x16x32_bf16 v[40:43], a[104:107], a[24:27], v[40:43]
    buffer_load_dwordx4 v3, s[4:7], s30 offen offset:1024 nt lds
    v_mfma_f32_16x16x32_bf16 v[40:43], a[108:111], a[28:31], v[40:43]
    ds_read_b64_tr_b16 a[176:177], v12 offset:0
    v_exp_f32 v32, v32
    v_mfma_f32_16x16x32_bf16 v[44:47], a[112:115], a[16:19], v[20:23]
    ds_read_b64_tr_b16 a[178:179], v12 offset:8192
    v_exp_f32 v33, v33
    v_mfma_f32_16x16x32_bf16 v[44:47], a[116:119], a[20:23], v[44:47]
    ds_read_b64_tr_b16 a[180:181], v13 offset:0
    v_cvt_pk_bf16_f32 v48, v32, v33
    v_mfma_f32_16x16x32_bf16 v[44:47], a[120:123], a[24:27], v[44:47]
    ds_read_b64_tr_b16 a[182:183], v13 offset:8192
    v_exp_f32 v34, v34
    v_mfma_f32_16x16x32_bf16 v[44:47], a[124:127], a[28:31], v[44:47]
    ds_read_b64_tr_b16 a[184:185], v14 offset:0
    v_exp_f32 v35, v35
    v_mfma_f32_16x16x32_bf16 v[224:227], a[192:195], v[52:55], v[224:227]
    ds_read_b64_tr_b16 a[186:187], v14 offset:8192
    v_cvt_pk_bf16_f32 v49, v34, v35
    v_mfma_f32_16x16x32_bf16 v[228:231], a[196:199], v[52:55], v[228:231]
    buffer_load_dwordx4 v2, s[4:7], s30 offen offset:2048 nt lds
    v_mfma_f32_16x16x32_bf16 v[232:235], a[200:203], v[52:55], v[232:235]
    ds_read_b64_tr_b16 a[188:189], v15 offset:0
    v_exp_f32 v36, v36
    v_mfma_f32_16x16x32_bf16 v[236:239], a[204:207], v[52:55], v[236:239]
    ds_read_b64_tr_b16 a[190:191], v15 offset:8192
    v_exp_f32 v37, v37
    v_mfma_f32_16x16x32_bf16 v[240:243], a[208:211], v[52:55], v[240:243]
    v_exp_f32 v38, v38
    v_mfma_f32_16x16x32_bf16 v[244:247], a[212:215], v[52:55], v[244:247]
    v_exp_f32 v39, v39
    v_mfma_f32_16x16x32_bf16 v[248:251], a[216:219], v[52:55], v[248:251]
    buffer_load_dwordx4 v3, s[4:7], s30 offen offset:3072 nt lds
    v_mfma_f32_16x16x32_bf16 v[252:255], a[220:223], v[52:55], v[252:255]
    v_cvt_pk_bf16_f32 v50, v36, v37
    v_cvt_pk_bf16_f32 v51, v38, v39
    v_mfma_f32_16x16x32_bf16 a[244:247], a[248:251], v[52:55], a[244:247]
    s_branch L_evenA
L_loopA:
    v_mfma_f32_16x16x32_bf16 v[32:35], a[128:131], a[32:35], v[56:59]
    s_mov_b32 m0, s99
    s_add_u32 s99, s99, s34
    v_mfma_f32_16x16x32_bf16 v[32:35], a[132:135], a[36:39], v[32:35]
    ds_read_b128 a[96:99], v4 offset:0
    v_add_u32 v8, s34, v8
    v_mfma_f32_16x16x32_bf16 v[32:35], a[136:139], a[40:43], v[32:35]
    v_exp_f32 v40, v40
    v_mfma_f32_16x16x32_bf16 v[32:35], a[140:143], a[44:47], v[32:35]
    buffer_load_dwordx4 v2, s[4:7], s30 offen offset:0 nt lds
    v_mfma_f32_16x16x32_bf16 v[36:39], a[144:147], a[32:35], v[56:59]
    v_exp_f32 v41, v41
    v_mfma_f32_16x16x32_bf16 v[36:39], a[148:151], a[36:39], v[36:39]
    ds_read_b128 a[100:103], v5 offset:0
    v_add_u32 v9, s34, v9
    v_mfma_f32_16x16x32_bf16 v[36:39], a[152:155], a[40:43], v[36:39]
    v_cvt_pk_bf16_f32 v52, v40, v41
    v_mfma_f32_16x16x32_bf16 v[36:39], a[156:159], a[44:47], v[36:39]
    v_exp_f32 v42, v42
    v_mfma_f32_16x16x32_bf16 v[64:67], a[192:195], v[48:51], v[64:67]
    v_exp_f32 v43, v43
    v_mfma_f32_16x16x32_bf16 v[68:71], a[196:199], v[48:51], v[68:71]
    ds_read_b128 a[104:107], v6 offset:0
    v_add_u32 v10, s34, v10
    v_mfma_f32_16x16x32_bf16 v[72:75], a[200:203], v[48:51], v[72:75]
    v_cvt_pk_bf16_f32 v53, v42, v43
    v_mfma_f32_16x16x32_bf16 v[76:79], a[204:207], v[48:51], v[76:79]
    buffer_load_dwordx4 v3, s[4:7], s30 offen offset:1024 nt lds
    v_mfma_f32_16x16x32_bf16 v[80:83], a[208:211], v[48:51], v[80:83]
    v_exp_f32 v44, v44
    v_mfma_f32_16x16x32_bf16 v[84:87], a[212:215], v[48:51], v[84:87]
    ds_read_b128 a[108:111], v7 offset:0
    v_add_u32 v11, s34, v11
    v_mfma_f32_16x16x32_bf16 v[88:91], a[216:219], v[48:51], v[88:91]
    v_exp_f32 v45, v45
    v_mfma_f32_16x16x32_bf16 v[92:95], a[220:223], v[48:51], v[92:95]
    v_cvt_pk_bf16_f32 v54, v44, v45
    v_mfma_f32_16x16x32_bf16 a[224:227], a[248:251], v[48:51], a[224:227]
    v_exp_f32 v46, v46
    v_mfma_f32_16x16x32_bf16 v[40:43], a[128:131], a[48:51], v[60:63]
    v_exp_f32 v47, v47
    v_mfma_f32_16x16x32_bf16 v[40:43], a[132:135], a[52:55], v[40:43]
    ds_read_b128 a[112:115], v4 offset:8192
    v_add_u32 v12, s34, v12
    v_mfma_f32_16x16x32_bf16 v[40:43], a[136:139], a[56:59], v[40:43]
    v_cvt_pk_bf16_f32 v55, v46, v47
    v_mfma_f32_16x16x32_bf16 v[40:43], a[140:143], a[60:63], v[40:43]
    buffer_load_dwordx4 v2, s[4:7], s30 offen offset:2048 nt lds
    v_mfma_f32_16x16x32_bf16 v[44:47], a[144:147], a[48:51], v[60:63]
    v_exp_f32 v32, v32
    v_mfma_f32_16x16x32_bf16 v[44:47], a[148:151], a[52:55], v[44:47]
    ds_read_b128 a[116:119], v5 offset:8192
    v_add_u32 v13, s34, v13
    v_mfma_f32_16x16x32_bf16 v[44:47], a[152:155], a[56:59], v[44:47]
    v_exp_f32 v33, v33
    v_mfma_f32_16x16x32_bf16 v[44:47], a[156:159], a[60:63], v[44:47]
    v_cvt_pk_bf16_f32 v48, v32, v33
    v_mfma_f32_16x16x32_bf16 v[96:99], a[192:195], v[52:55], v[96:99]
    v_exp_f32 v34, v34
    v_mfma_f32_16x16x32_bf16 v[100:103], a[196:199], v[52:55], v[100:103]
    ds_read_b128 a[120:123], v6 offset:8192
    v_add_u32 v14, s34, v14
    v_mfma_f32_16x16x32_bf16 v[104:107], a[200:203], v[52:55], v[104:107]
    v_exp_f32 v35, v35
    v_mfma_f32_16x16x32_bf16 v[108:111], a[204:207], v[52:55], v[108:111]
    buffer_load_dwordx4 v3, s[4:7], s30 offen offset:3072 nt lds
    v_mfma_f32_16x16x32_bf16 v[112:115], a[208:211], v[52:55], v[112:115]
    v_cvt_pk_bf16_f32 v49, v34, v35
    v_mfma_f32_16x16x32_bf16 v[116:119], a[212:215], v[52:55], v[116:119]
    ds_read_b128 a[124:127], v7 offset:8192
    v_add_u32 v15, s34, v15
    v_mfma_f32_16x16x32_bf16 v[120:123], a[216:219], v[52:55], v[120:123]
    v_exp_f32 v36, v36
    v_mfma_f32_16x16x32_bf16 v[124:127], a[220:223], v[52:55], v[124:127]
    v_exp_f32 v37, v37
    v_mfma_f32_16x16x32_bf16 a[228:231], a[248:251], v[52:55], a[228:231]
    v_cvt_pk_bf16_f32 v50, v36, v37
    v_mfma_f32_16x16x32_bf16 v[32:35], a[128:131], a[64:67], v[24:27]
    v_exp_f32 v38, v38
    v_mfma_f32_16x16x32_bf16 v[32:35], a[132:135], a[68:71], v[32:35]
    ds_read_b64_tr_b16 a[160:161], v8 offset:0
    v_mfma_f32_16x16x32_bf16 v[32:35], a[136:139], a[72:75], v[32:35]
    v_exp_f32 v39, v39
    v_mfma_f32_16x16x32_bf16 v[32:35], a[140:143], a[76:79], v[32:35]
    v_cvt_pk_bf16_f32 v51, v38, v39
    v_mfma_f32_16x16x32_bf16 v[36:39], a[144:147], a[64:67], v[24:27]
    v_mfma_f32_16x16x32_bf16 v[36:39], a[148:151], a[68:71], v[36:39]
    ds_read_b64_tr_b16 a[162:163], v8 offset:8192
    v_mfma_f32_16x16x32_bf16 v[36:39], a[152:155], a[72:75], v[36:39]
    v_mfma_f32_16x16x32_bf16 v[36:39], a[156:159], a[76:79], v[36:39]
    v_exp_f32 v40, v40
    v_mfma_f32_16x16x32_bf16 v[128:131], a[192:195], v[48:51], v[128:131]
    v_exp_f32 v41, v41
    v_mfma_f32_16x16x32_bf16 v[132:135], a[196:199], v[48:51], v[132:135]
    ds_read_b64_tr_b16 a[164:165], v9 offset:0
    v_cvt_pk_bf16_f32 v52, v40, v41
    v_mfma_f32_16x16x32_bf16 v[136:139], a[200:203], v[48:51], v[136:139]
    v_mfma_f32_16x16x32_bf16 v[140:143], a[204:207], v[48:51], v[140:143]
    v_exp_f32 v42, v42
    v_mfma_f32_16x16x32_bf16 v[144:147], a[208:211], v[48:51], v[144:147]
    v_exp_f32 v43, v43
    v_mfma_f32_16x16x32_bf16 v[148:151], a[212:215], v[48:51], v[148:151]
    ds_read_b64_tr_b16 a[166:167], v9 offset:8192
    v_cvt_pk_bf16_f32 v53, v42, v43
    v_mfma_f32_16x16x32_bf16 v[152:155], a[216:219], v[48:51], v[152:155]
    v_exp_f32 v44, v44
    v_mfma_f32_16x16x32_bf16 v[156:159], a[220:223], v[48:51], v[156:159]
    v_exp_f32 v45, v45
    v_mfma_f32_16x16x32_bf16 a[232:235], a[248:251], v[48:51], a[232:235]
    v_cvt_pk_bf16_f32 v54, v44, v45
    v_mfma_f32_16x16x32_bf16 v[40:43], a[128:131], a[80:83], v[28:31]
    v_exp_f32 v46, v46
    v_mfma_f32_16x16x32_bf16 v[40:43], a[132:135], a[84:87], v[40:43]
    ds_read_b64_tr_b16 a[168:169], v10 offset:0
    v_mfma_f32_16x16x32_bf16 v[40:43], a[136:139], a[88:91], v[40:43]
    v_exp_f32 v47, v47
    v_mfma_f32_16x16x32_bf16 v[40:43], a[140:143], a[92:95], v[40:43]
    v_cvt_pk_bf16_f32 v55, v46, v47
    v_mfma_f32_16x16x32_bf16 v[44:47], a[144:147], a[80:83], v[28:31]
    v_mfma_f32_16x16x32_bf16 v[44:47], a[148:151], a[84:87], v[44:47]
    ds_read_b64_tr_b16 a[170:171], v10 offset:8192
    v_mfma_f32_16x16x32_bf16 v[44:47], a[152:155], a[88:91], v[44:47]
    v_mfma_f32_16x16x32_bf16 v[44:47], a[156:159], a[92:95], v[44:47]
    v_exp_f32 v32, v32
    v_mfma_f32_16x16x32_bf16 v[160:163], a[192:195], v[52:55], v[160:163]
    v_exp_f32 v33, v33
    v_mfma_f32_16x16x32_bf16 v[164:167], a[196:199], v[52:55], v[164:167]
    ds_read_b64_tr_b16 a[172:173], v11 offset:0
    v_cvt_pk_bf16_f32 v48, v32, v33
    v_mfma_f32_16x16x32_bf16 v[168:171], a[200:203], v[52:55], v[168:171]
    v_mfma_f32_16x16x32_bf16 v[172:175], a[204:207], v[52:55], v[172:175]
    v_exp_f32 v34, v34
    v_mfma_f32_16x16x32_bf16 v[176:179], a[208:211], v[52:55], v[176:179]
    v_exp_f32 v35, v35
    v_mfma_f32_16x16x32_bf16 v[180:183], a[212:215], v[52:55], v[180:183]
    ds_read_b64_tr_b16 a[174:175], v11 offset:8192
    v_cvt_pk_bf16_f32 v49, v34, v35
    v_mfma_f32_16x16x32_bf16 v[184:187], a[216:219], v[52:55], v[184:187]
    v_exp_f32 v36, v36
    v_mfma_f32_16x16x32_bf16 v[188:191], a[220:223], v[52:55], v[188:191]
    v_exp_f32 v37, v37
    v_mfma_f32_16x16x32_bf16 a[236:239], a[248:251], v[52:55], a[236:239]
    v_cvt_pk_bf16_f32 v50, v36, v37
    s_waitcnt lgkmcnt(8)
    v_mfma_f32_16x16x32_bf16 v[32:35], a[96:99], a[0:3], v[16:19]
    v_exp_f32 v38, v38
    v_mfma_f32_16x16x32_bf16 v[32:35], a[100:103], a[4:7], v[32:35]
    ds_read_b64_tr_b16 a[176:177], v12 offset:0
    v_mfma_f32_16x16x32_bf16 v[32:35], a[104:107], a[8:11], v[32:35]
    v_exp_f32 v39, v39
    v_mfma_f32_16x16x32_bf16 v[32:35], a[108:111], a[12:15], v[32:35]
    v_cvt_pk_bf16_f32 v51, v38, v39
    v_mfma_f32_16x16x32_bf16 v[36:39], a[112:115], a[0:3], v[16:19]
    ds_read_b64_tr_b16 a[178:179], v12 offset:8192
    v_mfma_f32_16x16x32_bf16 v[36:39], a[116:119], a[4:7], v[36:39]
    v_exp_f32 v40, v40
    v_mfma_f32_16x16x32_bf16 v[36:39], a[120:123], a[8:11], v[36:39]
    v_exp_f32 v41, v41
    v_mfma_f32_16x16x32_bf16 v[36:39], a[124:127], a[12:15], v[36:39]
    ds_read_b64_tr_b16 a[180:181], v13 offset:0
    v_cvt_pk_bf16_f32 v52, v40, v41
    v_mfma_f32_16x16x32_bf16 v[192:195], a[192:195], v[48:51], v[192:195]
    v_exp_f32 v42, v42
    v_mfma_f32_16x16x32_bf16 v[196:199], a[196:199], v[48:51], v[196:199]
    v_exp_f32 v43, v43
    v_mfma_f32_16x16x32_bf16 v[200:203], a[200:203], v[48:51], v[200:203]
    ds_read_b64_tr_b16 a[182:183], v13 offset:8192
    v_cvt_pk_bf16_f32 v53, v42, v43
    v_mfma_f32_16x16x32_bf16 v[204:207], a[204:207], v[48:51], v[204:207]
    v_exp_f32 v44, v44
    v_mfma_f32_16x16x32_bf16 v[208:211], a[208:211], v[48:51], v[208:211]
    v_exp_f32 v45, v45
    v_mfma_f32_16x16x32_bf16 v[212:215], a[212:215], v[48:51], v[212:215]
    ds_read_b64_tr_b16 a[184:185], v14 offset:0
    v_cvt_pk_bf16_f32 v54, v44, v45
    v_mfma_f32_16x16x32_bf16 v[216:219], a[216:219], v[48:51], v[216:219]
    v_mfma_f32_16x16x32_bf16 v[220:223], a[220:223], v[48:51], v[220:223]
    v_mfma_f32_16x16x32_bf16 a[240:243], a[248:251], v[48:51], a[240:243]
    v_exp_f32 v46, v46
    v_mfma_f32_16x16x32_bf16 v[40:43], a[96:99], a[16:19], v[20:23]
    v_exp_f32 v47, v47
    v_mfma_f32_16x16x32_bf16 v[40:43], a[100:103], a[20:23], v[40:43]
    ds_read_b64_tr_b16 a[186:187], v14 offset:8192
    v_cvt_pk_bf16_f32 v55, v46, v47
    v_mfma_f32_16x16x32_bf16 v[40:43], a[104:107], a[24:27], v[40:43]
    v_mfma_f32_16x16x32_bf16 v[40:43], a[108:111], a[28:31], v[40:43]
    v_mfma_f32_16x16x32_bf16 v[44:47], a[112:115], a[16:19], v[20:23]
    ds_read_b64_tr_b16 a[188:189], v15 offset:0
    v_mfma_f32_16x16x32_bf16 v[44:47], a[116:119], a[20:23], v[44:47]
    v_exp_f32 v32, v32
    v_mfma_f32_16x16x32_bf16 v[44:47], a[120:123], a[24:27], v[44:47]
    v_exp_f32 v33, v33
    v_mfma_f32_16x16x32_bf16 v[44:47], a[124:127], a[28:31], v[44:47]
    ds_read_b64_tr_b16 a[190:191], v15 offset:8192
    v_cvt_pk_bf16_f32 v48, v32, v33
    v_mfma_f32_16x16x32_bf16 v[224:227], a[192:195], v[52:55], v[224:227]
    v_exp_f32 v34, v34
    v_mfma_f32_16x16x32_bf16 v[228:231], a[196:199], v[52:55], v[228:231]
    v_exp_f32 v35, v35
    v_mfma_f32_16x16x32_bf16 v[232:235], a[200:203], v[52:55], v[232:235]
    v_cvt_pk_bf16_f32 v49, v34, v35
    v_mfma_f32_16x16x32_bf16 v[236:239], a[204:207], v[52:55], v[236:239]
    v_exp_f32 v36, v36
    v_mfma_f32_16x16x32_bf16 v[240:243], a[208:211], v[52:55], v[240:243]
    v_exp_f32 v37, v37
    v_mfma_f32_16x16x32_bf16 v[244:247], a[212:215], v[52:55], v[244:247]
    v_cvt_pk_bf16_f32 v50, v36, v37
    v_mfma_f32_16x16x32_bf16 v[248:251], a[216:219], v[52:55], v[248:251]
    v_exp_f32 v38, v38
    v_mfma_f32_16x16x32_bf16 v[252:255], a[220:223], v[52:55], v[252:255]
    v_exp_f32 v39, v39
    v_mfma_f32_16x16x32_bf16 a[244:247], a[248:251], v[52:55], a[244:247]
    v_cvt_pk_bf16_f32 v51, v38, v39
L_evenA:
    v_mfma_f32_16x16x32_bf16 v[32:35], a[96:99], a[32:35], v[56:59]
    v_mfma_f32_16x16x32_bf16 v[32:35], a[100:103], a[36:39], v[32:35]
    ds_read_b128 a[128:131], v4 offset:16384
    v_mfma_f32_16x16x32_bf16 v[32:35], a[104:107], a[40:43], v[32:35]
    s_add_u32 m0, m0, 4096
    v_mfma_f32_16x16x32_bf16 v[32:35], a[108:111], a[44:47], v[32:35]
    buffer_load_dwordx4 v2, s[8:11], s30 offen offset:0 nt lds
    v_mfma_f32_16x16x32_bf16 v[36:39], a[112:115], a[32:35], v[56:59]
    v_exp_f32 v40, v40
    v_mfma_f32_16x16x32_bf16 v[36:39], a[116:119], a[36:39], v[36:39]
    ds_read_b128 a[132:135], v5 offset:16384
    v_mfma_f32_16x16x32_bf16 v[36:39], a[120:123], a[40:43], v[36:39]
    v_exp_f32 v41, v41
    v_mfma_f32_16x16x32_bf16 v[36:39], a[124:127], a[44:47], v[36:39]
    v_cvt_pk_bf16_f32 v52, v40, v41
    s_waitcnt lgkmcnt(2)
    v_mfma_f32_16x16x32_bf16 v[64:67], a[160:163], v[48:51], v[64:67]
    v_exp_f32 v42, v42
    v_mfma_f32_16x16x32_bf16 v[68:71], a[164:167], v[48:51], v[68:71]
    ds_read_b128 a[136:139], v6 offset:16384
    v_mfma_f32_16x16x32_bf16 v[72:75], a[168:171], v[48:51], v[72:75]
    v_exp_f32 v43, v43
    v_mfma_f32_16x16x32_bf16 v[76:79], a[172:175], v[48:51], v[76:79]
    buffer_load_dwordx4 v3, s[8:11], s30 offen offset:1024 nt lds
    v_mfma_f32_16x16x32_bf16 v[80:83], a[176:179], v[48:51], v[80:83]
    v_exp_f32 v44, v44
    v_mfma_f32_16x16x32_bf16 v[84:87], a[180:183], v[48:51], v[84:87]
    ds_read_b128 a[140:143], v7 offset:16384
    v_cvt_pk_bf16_f32 v53, v42, v43
    v_mfma_f32_16x16x32_bf16 v[88:91], a[184:187], v[48:51], v[88:91]
    v_exp_f32 v45, v45
    v_mfma_f32_16x16x32_bf16 v[92:95], a[188:191], v[48:51], v[92:95]
    v_cvt_pk_bf16_f32 v54, v44, v45
    v_mfma_f32_16x16x32_bf16 a[224:227], a[248:251], v[48:51], a[224:227]
    v_exp_f32 v46, v46
    v_mfma_f32_16x16x32_bf16 v[40:43], a[96:99], a[48:51], v[60:63]
    v_exp_f32 v47, v47
    v_mfma_f32_16x16x32_bf16 v[40:43], a[100:103], a[52:55], v[40:43]
    ds_read_b128 a[144:147], v4 offset:24576
    v_cvt_pk_bf16_f32 v55, v46, v47
    v_mfma_f32_16x16x32_bf16 v[40:43], a[104:107], a[56:59], v[40:43]
    v_exp_f32 v32, v32
    v_mfma_f32_16x16x32_bf16 v[40:43], a[108:111], a[60:63], v[40:43]
    buffer_load_dwordx4 v2, s[8:11], s30 offen offset:2048 nt lds
    v_mfma_f32_16x16x32_bf16 v[44:47], a[112:115], a[48:51], v[60:63]
    v_exp_f32 v33, v33
    v_mfma_f32_16x16x32_bf16 v[44:47], a[116:119], a[52:55], v[44:47]
    ds_read_b128 a[148:151], v5 offset:24576
    v_cvt_pk_bf16_f32 v48, v32, v33
    v_mfma_f32_16x16x32_bf16 v[44:47], a[120:123], a[56:59], v[44:47]
    v_exp_f32 v34, v34
    v_mfma_f32_16x16x32_bf16 v[44:47], a[124:127], a[60:63], v[44:47]
    s_add_u32 s95, s95, 2048
    v_mfma_f32_16x16x32_bf16 v[96:99], a[160:163], v[52:55], v[96:99]
    v_exp_f32 v35, v35
    v_mfma_f32_16x16x32_bf16 v[100:103], a[164:167], v[52:55], v[100:103]
    ds_read_b128 a[152:155], v6 offset:24576
    v_cvt_pk_bf16_f32 v49, v34, v35
    v_mfma_f32_16x16x32_bf16 v[104:107], a[168:171], v[52:55], v[104:107]
    v_exp_f32 v36, v36
    v_mfma_f32_16x16x32_bf16 v[108:111], a[172:175], v[52:55], v[108:111]
    buffer_load_dwordx4 v3, s[8:11], s30 offen offset:3072 nt lds
    v_mfma_f32_16x16x32_bf16 v[112:115], a[176:179], v[52:55], v[112:115]
    v_exp_f32 v37, v37
    v_mfma_f32_16x16x32_bf16 v[116:119], a[180:183], v[52:55], v[116:119]
    ds_read_b128 a[156:159], v7 offset:24576
    v_cvt_pk_bf16_f32 v50, v36, v37
    v_mfma_f32_16x16x32_bf16 v[120:123], a[184:187], v[52:55], v[120:123]
    v_exp_f32 v38, v38
    v_mfma_f32_16x16x32_bf16 v[124:127], a[188:191], v[52:55], v[124:127]
    s_mov_b32 m0, s95
    v_mfma_f32_16x16x32_bf16 a[228:231], a[248:251], v[52:55], a[228:231]
    s_cmp_eq_u32 s99, s57
    s_cselect_b32 s34, s32, 32768
    v_mfma_f32_16x16x32_bf16 v[32:35], a[96:99], a[64:67], v[24:27]
    v_exp_f32 v39, v39
    v_mfma_f32_16x16x32_bf16 v[32:35], a[100:103], a[68:71], v[32:35]
    ds_read_b64_tr_b16 a[192:193], v8 offset:16384
    v_cvt_pk_bf16_f32 v51, v38, v39
    v_mfma_f32_16x16x32_bf16 v[32:35], a[104:107], a[72:75], v[32:35]
    v_exp_f32 v40, v40
    v_mfma_f32_16x16x32_bf16 v[32:35], a[108:111], a[76:79], v[32:35]
    v_add_u32 v4, s34, v4
    v_mfma_f32_16x16x32_bf16 v[36:39], a[112:115], a[64:67], v[24:27]
    v_exp_f32 v41, v41
    v_mfma_f32_16x16x32_bf16 v[36:39], a[116:119], a[68:71], v[36:39]
    ds_read_b64_tr_b16 a[194:195], v8 offset:24576
    v_cvt_pk_bf16_f32 v52, v40, v41
    v_mfma_f32_16x16x32_bf16 v[36:39], a[120:123], a[72:75], v[36:39]
    v_exp_f32 v42, v42
    v_mfma_f32_16x16x32_bf16 v[36:39], a[124:127], a[76:79], v[36:39]
    buffer_load_dwordx4 v2, s[84:87], m0 offen offset:0 nt lds
    v_mfma_f32_16x16x32_bf16 v[128:131], a[160:163], v[48:51], v[128:131]
    v_exp_f32 v43, v43
    v_mfma_f32_16x16x32_bf16 v[132:135], a[164:167], v[48:51], v[132:135]
    ds_read_b64_tr_b16 a[196:197], v9 offset:16384
    v_cvt_pk_bf16_f32 v53, v42, v43
    v_mfma_f32_16x16x32_bf16 v[136:139], a[168:171], v[48:51], v[136:139]
    v_mfma_f32_16x16x32_bf16 v[140:143], a[172:175], v[48:51], v[140:143]
    s_add_u32 s30, s30, 16384
    v_add_u32 v5, s34, v5
    v_mfma_f32_16x16x32_bf16 v[144:147], a[176:179], v[48:51], v[144:147]
    v_exp_f32 v44, v44
    v_mfma_f32_16x16x32_bf16 v[148:151], a[180:183], v[48:51], v[148:151]
    ds_read_b64_tr_b16 a[198:199], v9 offset:24576
    v_mfma_f32_16x16x32_bf16 v[152:155], a[184:187], v[48:51], v[152:155]
    v_exp_f32 v45, v45
    v_mfma_f32_16x16x32_bf16 v[156:159], a[188:191], v[48:51], v[156:159]
    v_add_u32 v6, s34, v6
    v_cvt_pk_bf16_f32 v54, v44, v45
    v_mfma_f32_16x16x32_bf16 a[232:235], a[248:251], v[48:51], a[232:235]
    v_exp_f32 v46, v46
    v_mfma_f32_16x16x32_bf16 v[40:43], a[96:99], a[80:83], v[28:31]
    v_exp_f32 v47, v47
    v_mfma_f32_16x16x32_bf16 v[40:43], a[100:103], a[84:87], v[40:43]
    ds_read_b64_tr_b16 a[200:201], v10 offset:16384
    v_cvt_pk_bf16_f32 v55, v46, v47
    v_mfma_f32_16x16x32_bf16 v[40:43], a[104:107], a[88:91], v[40:43]
    v_exp_f32 v32, v32
    v_mfma_f32_16x16x32_bf16 v[40:43], a[108:111], a[92:95], v[40:43]
    buffer_load_dwordx4 v3, s[84:87], m0 offen offset:1024 nt lds
    v_mfma_f32_16x16x32_bf16 v[44:47], a[112:115], a[80:83], v[28:31]
    v_exp_f32 v33, v33
    v_mfma_f32_16x16x32_bf16 v[44:47], a[116:119], a[84:87], v[44:47]
    ds_read_b64_tr_b16 a[202:203], v10 offset:24576
    v_cvt_pk_bf16_f32 v48, v32, v33
    v_mfma_f32_16x16x32_bf16 v[44:47], a[120:123], a[88:91], v[44:47]
    v_exp_f32 v34, v34
    v_mfma_f32_16x16x32_bf16 v[44:47], a[124:127], a[92:95], v[44:47]
    v_add_u32 v7, s34, v7
    v_mfma_f32_16x16x32_bf16 v[160:163], a[160:163], v[52:55], v[160:163]
    v_exp_f32 v35, v35
    v_mfma_f32_16x16x32_bf16 v[164:167], a[164:167], v[52:55], v[164:167]
    ds_read_b64_tr_b16 a[204:205], v11 offset:16384
    v_cvt_pk_bf16_f32 v49, v34, v35
    v_mfma_f32_16x16x32_bf16 v[168:171], a[168:171], v[52:55], v[168:171]
    v_mfma_f32_16x16x32_bf16 v[172:175], a[172:175], v[52:55], v[172:175]
    v_exp_f32 v36, v36
    v_mfma_f32_16x16x32_bf16 v[176:179], a[176:179], v[52:55], v[176:179]
    v_exp_f32 v37, v37
    v_mfma_f32_16x16x32_bf16 v[180:183], a[180:183], v[52:55], v[180:183]
    ds_read_b64_tr_b16 a[206:207], v11 offset:24576
    v_cvt_pk_bf16_f32 v50, v36, v37
    v_mfma_f32_16x16x32_bf16 v[184:187], a[184:187], v[52:55], v[184:187]
    v_exp_f32 v38, v38
    v_mfma_f32_16x16x32_bf16 v[188:191], a[188:191], v[52:55], v[188:191]
    v_exp_f32 v39, v39
    v_mfma_f32_16x16x32_bf16 a[236:239], a[248:251], v[52:55], a[236:239]
    v_cvt_pk_bf16_f32 v51, v38, v39
    s_waitcnt lgkmcnt(8)
    v_mfma_f32_16x16x32_bf16 v[32:35], a[128:131], a[0:3], v[16:19]
    v_mfma_f32_16x16x32_bf16 v[32:35], a[132:135], a[4:7], v[32:35]
    ds_read_b64_tr_b16 a[208:209], v12 offset:16384
    v_mfma_f32_16x16x32_bf16 v[32:35], a[136:139], a[8:11], v[32:35]
    v_exp_f32 v40, v40
    v_mfma_f32_16x16x32_bf16 v[32:35], a[140:143], a[12:15], v[32:35]
    v_exp_f32 v41, v41
    v_mfma_f32_16x16x32_bf16 v[36:39], a[144:147], a[0:3], v[16:19]
    ds_read_b64_tr_b16 a[210:211], v12 offset:24576
    v_cvt_pk_bf16_f32 v52, v40, v41
    v_mfma_f32_16x16x32_bf16 v[36:39], a[148:151], a[4:7], v[36:39]
    v_exp_f32 v42, v42
    v_mfma_f32_16x16x32_bf16 v[36:39], a[152:155], a[8:11], v[36:39]
    v_exp_f32 v43, v43
    v_mfma_f32_16x16x32_bf16 v[36:39], a[156:159], a[12:15], v[36:39]
    ds_read_b64_tr_b16 a[212:213], v13 offset:16384
    v_cvt_pk_bf16_f32 v53, v42, v43
    v_mfma_f32_16x16x32_bf16 v[192:195], a[160:163], v[48:51], v[192:195]
    v_exp_f32 v44, v44
    v_mfma_f32_16x16x32_bf16 v[196:199], a[164:167], v[48:51], v[196:199]
    v_exp_f32 v45, v45
    v_mfma_f32_16x16x32_bf16 v[200:203], a[168:171], v[48:51], v[200:203]
    ds_read_b64_tr_b16 a[214:215], v13 offset:24576
    v_cvt_pk_bf16_f32 v54, v44, v45
    v_mfma_f32_16x16x32_bf16 v[204:207], a[172:175], v[48:51], v[204:207]
    v_exp_f32 v46, v46
    v_mfma_f32_16x16x32_bf16 v[208:211], a[176:179], v[48:51], v[208:211]
    v_exp_f32 v47, v47
    v_mfma_f32_16x16x32_bf16 v[212:215], a[180:183], v[48:51], v[212:215]
    ds_read_b64_tr_b16 a[216:217], v14 offset:16384
    v_cvt_pk_bf16_f32 v55, v46, v47
    v_mfma_f32_16x16x32_bf16 v[216:219], a[184:187], v[48:51], v[216:219]
    v_mfma_f32_16x16x32_bf16 v[220:223], a[188:191], v[48:51], v[220:223]
    v_mfma_f32_16x16x32_bf16 a[240:243], a[248:251], v[48:51], a[240:243]
    v_exp_f32 v32, v32
    v_mfma_f32_16x16x32_bf16 v[40:43], a[128:131], a[16:19], v[20:23]
    v_exp_f32 v33, v33
    v_mfma_f32_16x16x32_bf16 v[40:43], a[132:135], a[20:23], v[40:43]
    ds_read_b64_tr_b16 a[218:219], v14 offset:24576
    v_cvt_pk_bf16_f32 v48, v32, v33
    v_mfma_f32_16x16x32_bf16 v[40:43], a[136:139], a[24:27], v[40:43]
    v_exp_f32 v34, v34
    v_mfma_f32_16x16x32_bf16 v[40:43], a[140:143], a[28:31], v[40:43]
    v_exp_f32 v35, v35
    v_mfma_f32_16x16x32_bf16 v[44:47], a[144:147], a[16:19], v[20:23]
    ds_read_b64_tr_b16 a[220:221], v15 offset:16384
    v_cvt_pk_bf16_f32 v49, v34, v35
    v_mfma_f32_16x16x32_bf16 v[44:47], a[148:151], a[20:23], v[44:47]
    v_exp_f32 v36, v36
    v_mfma_f32_16x16x32_bf16 v[44:47], a[152:155], a[24:27], v[44:47]
    v_exp_f32 v37, v37
    v_mfma_f32_16x16x32_bf16 v[44:47], a[156:159], a[28:31], v[44:47]
    ds_read_b64_tr_b16 a[222:223], v15 offset:24576
    v_cvt_pk_bf16_f32 v50, v36, v37
    v_mfma_f32_16x16x32_bf16 v[224:227], a[160:163], v[52:55], v[224:227]
    v_exp_f32 v38, v38
    v_mfma_f32_16x16x32_bf16 v[228:231], a[164:167], v[52:55], v[228:231]
    v_exp_f32 v39, v39
    v_mfma_f32_16x16x32_bf16 v[232:235], a[168:171], v[52:55], v[232:235]
    s_add_u32 s35, s35, 1
    v_cvt_pk_bf16_f32 v51, v38, v39
    v_mfma_f32_16x16x32_bf16 v[236:239], a[172:175], v[52:55], v[236:239]
    v_mfma_f32_16x16x32_bf16 v[240:243], a[176:179], v[52:55], v[240:243]
    s_cmp_lt_u32 s35, s97
    v_mfma_f32_16x16x32_bf16 v[244:247], a[180:183], v[52:55], v[244:247]
    v_mfma_f32_16x16x32_bf16 v[248:251], a[184:187], v[52:55], v[248:251]
    s_waitcnt vmcnt(12) lgkmcnt(0)
    s_barrier
    v_mfma_f32_16x16x32_bf16 v[252:255], a[188:191], v[52:55], v[252:255]
    v_mfma_f32_16x16x32_bf16 a[244:247], a[248:251], v[52:55], a[244:247]
    s_cbranch_scc1 L_loopA
    s_cmp_eq_u32 s35, 7
    s_cbranch_scc1 L_mid
    s_add_u32 s97, s97, 1
    s_cmp_eq_u32 s35, 5
    s_cselect_b64 s[4:5], s[16:17], s[20:21]
    s_cselect_b64 s[8:9], s[52:53], s[24:25]
    s_cselect_b32 s30, s42, s41
    s_branch L_loopA
L_mid:
    v_mfma_f32_16x16x32_bf16 v[32:35], a[128:131], a[32:35], v[56:59]
    s_add_u32 m0, s29, 32768
    s_add_u32 s49, s98, 32768
    v_mfma_f32_16x16x32_bf16 v[32:35], a[132:135], a[36:39], v[32:35]
    v_add_u32 v16, s49, v4
    v_add_u32 v17, s49, v5
    v_mfma_f32_16x16x32_bf16 v[32:35], a[136:139], a[40:43], v[32:35]
    v_add_u32 v18, s49, v6
    v_add_u32 v19, s49, v7
    v_mfma_f32_16x16x32_bf16 v[32:35], a[140:143], a[44:47], v[32:35]
    v_exp_f32 v40, v40
    v_exp_f32 v41, v41
    v_mfma_f32_16x16x32_bf16 v[36:39], a[144:147], a[32:35], v[56:59]
    ds_read_b128 a[0:3], v16 offset:0
    ds_read_b128 a[4:7], v17 offset:0
    v_cvt_pk_bf16_f32 v52, v40, v41
    v_mfma_f32_16x16x32_bf16 v[36:39], a[148:151], a[36:39], v[36:39]
    ds_read_b128 a[8:11], v18 offset:0
    ds_read_b128 a[12:15], v19 offset:0
    v_mfma_f32_16x16x32_bf16 v[36:39], a[152:155], a[40:43], v[36:39]
    ds_read_b128 a[16:19], v16 offset:4096
    ds_read_b128 a[20:23], v17 offset:4096
    v_mfma_f32_16x16x32_bf16 v[36:39], a[156:159], a[44:47], v[36:39]
    ds_read_b128 a[24:27], v18 offset:4096
    ds_read_b128 a[28:31], v19 offset:4096
    v_mfma_f32_16x16x32_bf16 v[64:67], a[192:195], v[48:51], v[64:67]
    v_mbcnt_lo_u32_b32 v20, -1, 0
    v_mbcnt_hi_u32_b32 v20, -1, v20
    v_lshrrev_b32 v21, 5, v20
    v_xor_b32 v21, v21, v20
    v_and_b32 v21, 7, v21
    v_lshlrev_b32 v21, 4, v21
    v_mfma_f32_16x16x32_bf16 v[68:71], a[196:199], v[48:51], v[68:71]
    ds_read_b128 a[32:35], v16 offset:8192
    ds_read_b128 a[36:39], v17 offset:8192
    v_and_b32 v22, 15, v20
    v_lshl_add_u32 v21, v22, 8, v21
    v_bfe_u32 v23, v20, 4, 1
    v_lshl_add_u32 v21, v23, 3, v21
    s_add_u32 s39, s98, 98304
    v_mfma_f32_16x16x32_bf16 v[72:75], a[200:203], v[48:51], v[72:75]
    ds_read_b128 a[40:43], v18 offset:8192
    ds_read_b128 a[44:47], v19 offset:8192
    v_add_u32 v56, s39, v21
    v_lshrrev_b32 v20, 4, v20
    v_xor_b32 v22, v22, v20
    v_lshlrev_b32 v22, 4, v22
    v_lshl_add_u32 v22, v20, 8, v22
    v_xor_b32 v23, 64, v22
    v_mfma_f32_16x16x32_bf16 v[76:79], a[204:207], v[48:51], v[76:79]
    v_exp_f32 v42, v42
    v_exp_f32 v43, v43
    v_mfma_f32_16x16x32_bf16 v[80:83], a[208:211], v[48:51], v[80:83]
    v_xor_b32 v57, 32, v56
    v_xor_b32 v58, 64, v56
    s_mov_b64 s[46:47], 0
    s_movk_i32 s56, 0x3fff
    v_cvt_pk_bf16_f32 v53, v42, v43
    v_mfma_f32_16x16x32_bf16 v[84:87], a[212:215], v[48:51], v[84:87]
    v_add_u32 v4, 0xffff0000, v4
    v_add_u32 v5, 0xffff0000, v5
    v_mfma_f32_16x16x32_bf16 v[88:91], a[216:219], v[48:51], v[88:91]
    v_add_u32 v6, 0xffff0000, v6
    v_add_u32 v7, 0xffff0000, v7
    v_mfma_f32_16x16x32_bf16 v[92:95], a[220:223], v[48:51], v[92:95]
    v_add_u32 v8, 0xffff8000, v8
    v_add_u32 v9, 0xffff8000, v9
    v_mfma_f32_16x16x32_bf16 a[224:227], a[248:251], v[48:51], a[224:227]
    buffer_load_dwordx4 v2, s[4:7], s30 offen offset:0 nt lds
    v_add_u32 v10, 0xffff8000, v10
    v_add_u32 v11, 0xffff8000, v11
    v_mfma_f32_16x16x32_bf16 v[40:43], a[128:131], a[48:51], v[60:63]
    v_add_u32 v12, 0xffff8000, v12
    v_add_u32 v13, 0xffff8000, v13
    v_mfma_f32_16x16x32_bf16 v[40:43], a[132:135], a[52:55], v[40:43]
    v_add_u32 v14, 0xffff8000, v14
    v_add_u32 v15, 0xffff8000, v15
    v_exp_f32 v44, v44
    v_exp_f32 v45, v45
    v_mfma_f32_16x16x32_bf16 v[40:43], a[136:139], a[56:59], v[40:43]
    v_xor_b32 v59, 96, v56
    v_cvt_pk_bf16_f32 v54, v44, v45
    v_exp_f32 v46, v46
    v_exp_f32 v47, v47
    v_mfma_f32_16x16x32_bf16 v[40:43], a[140:143], a[60:63], v[40:43]
    v_cvt_pk_bf16_f32 v55, v46, v47
    v_exp_f32 v32, v32
    v_exp_f32 v33, v33
    v_mfma_f32_16x16x32_bf16 v[44:47], a[144:147], a[48:51], v[60:63]
    v_accvgpr_read_b32 v21, a224
    v_rcp_f32 v20, v21
    v_subrev_u32 v21, s50, v21
    v_cmp_le_u32 vcc, s51, v21
    v_pk_mul_f32 v[64:65], v[64:65], v[20:21] op_sel_hi:[1,0]
    v_pk_mul_f32 v[66:67], v[66:67], v[20:21] op_sel_hi:[1,0]
    v_pk_mul_f32 v[68:69], v[68:69], v[20:21] op_sel_hi:[1,0]
    v_pk_mul_f32 v[70:71], v[70:71], v[20:21] op_sel_hi:[1,0]
    v_pk_mul_f32 v[72:73], v[72:73], v[20:21] op_sel_hi:[1,0]
    v_pk_mul_f32 v[74:75], v[74:75], v[20:21] op_sel_hi:[1,0]
    v_pk_mul_f32 v[76:77], v[76:77], v[20:21] op_sel_hi:[1,0]
    v_pk_mul_f32 v[78:79], v[78:79], v[20:21] op_sel_hi:[1,0]
    v_pk_mul_f32 v[80:81], v[80:81], v[20:21] op_sel_hi:[1,0]
    v_pk_mul_f32 v[82:83], v[82:83], v[20:21] op_sel_hi:[1,0]
    v_pk_mul_f32 v[84:85], v[84:85], v[20:21] op_sel_hi:[1,0]
    v_pk_mul_f32 v[86:87], v[86:87], v[20:21] op_sel_hi:[1,0]
    v_pk_mul_f32 v[88:89], v[88:89], v[20:21] op_sel_hi:[1,0]
    v_pk_mul_f32 v[90:91], v[90:91], v[20:21] op_sel_hi:[1,0]
    v_pk_mul_f32 v[92:93], v[92:93], v[20:21] op_sel_hi:[1,0]
    v_pk_mul_f32 v[94:95], v[94:95], v[20:21] op_sel_hi:[1,0]
    s_or_b64 s[46:47], s[46:47], vcc
    v_cvt_pk_bf16_f32 v64, v64, v65
    v_cvt_pk_bf16_f32 v65, v66, v67
    v_cvt_pk_bf16_f32 v66, v68, v69
    v_cvt_pk_bf16_f32 v67, v70, v71
    v_cvt_pk_bf16_f32 v68, v72, v73
    v_cvt_pk_bf16_f32 v69, v74, v75
    v_cvt_pk_bf16_f32 v70, v76, v77
    v_cvt_pk_bf16_f32 v71, v78, v79
    v_cvt_pk_bf16_f32 v72, v80, v81
    v_cvt_pk_bf16_f32 v73, v82, v83
    v_cvt_pk_bf16_f32 v74, v84, v85
    v_cvt_pk_bf16_f32 v75, v86, v87
    v_cvt_pk_bf16_f32 v76, v88, v89
    v_cvt_pk_bf16_f32 v77, v90, v91
    v_cvt_pk_bf16_f32 v78, v92, v93
    v_cvt_pk_bf16_f32 v79, v94, v95
    v_cvt_pk_bf16_f32 v48, v32, v33
    v_mfma_f32_16x16x32_bf16 v[44:47], a[148:151], a[52:55], v[44:47]
    ds_write_b64 v56, v[64:65] offset:0
    v_mfma_f32_16x16x32_bf16 v[44:47], a[152:155], a[56:59], v[44:47]
    v_exp_f32 v34, v34
    v_exp_f32 v35, v35
    v_mfma_f32_16x16x32_bf16 v[44:47], a[156:159], a[60:63], v[44:47]
    ds_write_b64 v57, v[66:67] offset:0
    v_cvt_pk_bf16_f32 v49, v34, v35
    v_mfma_f32_16x16x32_bf16 v[96:99], a[192:195], v[52:55], v[96:99]
    v_xor_b32 v60, 128, v56
    v_xor_b32 v61, 160, v56
    v_mfma_f32_16x16x32_bf16 v[100:103], a[196:199], v[52:55], v[100:103]
    ds_write_b64 v58, v[68:69] offset:0
    v_mfma_f32_16x16x32_bf16 v[104:107], a[200:203], v[52:55], v[104:107]
    ds_write_b64 v59, v[70:71] offset:0
    v_mfma_f32_16x16x32_bf16 v[108:111], a[204:207], v[52:55], v[108:111]
    v_xor_b32 v62, 192, v56
    v_xor_b32 v63, 224, v56
    v_mfma_f32_16x16x32_bf16 v[112:115], a[208:211], v[52:55], v[112:115]
    ds_write_b64 v60, v[72:73] offset:0
    v_mfma_f32_16x16x32_bf16 v[116:119], a[212:215], v[52:55], v[116:119]
    buffer_load_dwordx4 v3, s[4:7], s30 offen offset:1024 nt lds
    v_mfma_f32_16x16x32_bf16 v[120:123], a[216:219], v[52:55], v[120:123]
    ds_write_b64 v61, v[74:75] offset:0
    v_mfma_f32_16x16x32_bf16 v[124:127], a[220:223], v[52:55], v[124:127]
    v_exp_f32 v36, v36
    v_exp_f32 v37, v37
    v_mfma_f32_16x16x32_bf16 a[228:231], a[248:251], v[52:55], a[228:231]
    ds_write_b64 v62, v[76:77] offset:0
    v_cvt_pk_bf16_f32 v50, v36, v37
    v_mfma_f32_16x16x32_bf16 v[32:35], a[128:131], a[64:67], v[24:27]
    v_exp_f32 v38, v38
    v_exp_f32 v39, v39
    v_mfma_f32_16x16x32_bf16 v[32:35], a[132:135], a[68:71], v[32:35]
    ds_write_b64 v63, v[78:79] offset:0
    v_cvt_pk_bf16_f32 v51, v38, v39
    v_mfma_f32_16x16x32_bf16 v[32:35], a[136:139], a[72:75], v[32:35]
    v_exp_f32 v40, v40
    v_exp_f32 v41, v41
    v_mfma_f32_16x16x32_bf16 v[32:35], a[140:143], a[76:79], v[32:35]
    ds_read_b128 v[80:83], v1 offset:0
    ds_read_b128 v[84:87], v1 offset:1024
    v_cvt_pk_bf16_f32 v52, v40, v41
    v_mfma_f32_16x16x32_bf16 v[36:39], a[144:147], a[64:67], v[24:27]
    ds_read_b128 v[88:91], v1 offset:2048
    ds_read_b128 v[92:95], v1 offset:3072
    v_accvgpr_read_b32 v21, a228
    v_rcp_f32 v20, v21
    v_subrev_u32 v21, s50, v21
    v_cmp_le_u32 vcc, s51, v21
    v_pk_mul_f32 v[96:97], v[96:97], v[20:21] op_sel_hi:[1,0]
    v_pk_mul_f32 v[98:99], v[98:99], v[20:21] op_sel_hi:[1,0]
    v_pk_mul_f32 v[100:101], v[100:101], v[20:21] op_sel_hi:[1,0]
    v_pk_mul_f32 v[102:103], v[102:103], v[20:21] op_sel_hi:[1,0]
    v_pk_mul_f32 v[104:105], v[104:105], v[20:21] op_sel_hi:[1,0]
    v_pk_mul_f32 v[106:107], v[106:107], v[20:21] op_sel_hi:[1,0]
    v_pk_mul_f32 v[108:109], v[108:109], v[20:21] op_sel_hi:[1,0]
    v_pk_mul_f32 v[110:111], v[110:111], v[20:21] op_sel_hi:[1,0]
    v_pk_mul_f32 v[112:113], v[112:113], v[20:21] op_sel_hi:[1,0]
    v_pk_mul_f32 v[114:115], v[114:115], v[20:21] op_sel_hi:[1,0]
    v_pk_mul_f32 v[116:117], v[116:117], v[20:21] op_sel_hi:[1,0]
    v_pk_mul_f32 v[118:119], v[118:119], v[20:21] op_sel_hi:[1,0]
    v_pk_mul_f32 v[120:121], v[120:121], v[20:21] op_sel_hi:[1,0]
    v_pk_mul_f32 v[122:123], v[122:123], v[20:21] op_sel_hi:[1,0]
    v_pk_mul_f32 v[124:125], v[124:125], v[20:21] op_sel_hi:[1,0]
    v_pk_mul_f32 v[126:127], v[126:127], v[20:21] op_sel_hi:[1,0]
    s_or_b64 s[46:47], s[46:47], vcc
    v_cvt_pk_bf16_f32 v96, v96, v97
    v_cvt_pk_bf16_f32 v97, v98, v99
    v_cvt_pk_bf16_f32 v98, v100, v101
    v_cvt_pk_bf16_f32 v99, v102, v103
    v_cvt_pk_bf16_f32 v100, v104, v105
    v_cvt_pk_bf16_f32 v101, v106, v107
    v_cvt_pk_bf16_f32 v102, v108, v109
    v_cvt_pk_bf16_f32 v103, v110, v111
    v_cvt_pk_bf16_f32 v104, v112, v113
    v_cvt_pk_bf16_f32 v105, v114, v115
    v_cvt_pk_bf16_f32 v106, v116, v117
    v_cvt_pk_bf16_f32 v107, v118, v119
    v_cvt_pk_bf16_f32 v108, v120, v121
    v_cvt_pk_bf16_f32 v109, v122, v123
    v_cvt_pk_bf16_f32 v110, v124, v125
    v_cvt_pk_bf16_f32 v111, v126, v127
    v_mfma_f32_16x16x32_bf16 v[36:39], a[148:151], a[68:71], v[36:39]
    ds_write_b64 v56, v[96:97] offset:4096
    v_mfma_f32_16x16x32_bf16 v[36:39], a[152:155], a[72:75], v[36:39]
    v_exp_f32 v42, v42
    v_exp_f32 v43, v43
    v_mfma_f32_16x16x32_bf16 v[36:39], a[156:159], a[76:79], v[36:39]
    ds_write_b64 v57, v[98:99] offset:4096
    v_cvt_pk_bf16_f32 v53, v42, v43
    v_mfma_f32_16x16x32_bf16 v[128:131], a[192:195], v[48:51], v[128:131]
    s_add_u32 s43, s40, 0
    s_waitcnt lgkmcnt(2)
    buffer_store_dwordx4 v[80:83], v22, s[12:15], s43 offen offset:0 sc1
    v_mfma_f32_16x16x32_bf16 v[132:135], a[196:199], v[48:51], v[132:135]
    ds_write_b64 v58, v[100:101] offset:4096
    v_mfma_f32_16x16x32_bf16 v[136:139], a[200:203], v[48:51], v[136:139]
    v_exp_f32 v44, v44
    v_exp_f32 v45, v45
    v_mfma_f32_16x16x32_bf16 v[140:143], a[204:207], v[48:51], v[140:143]
    ds_write_b64 v59, v[102:103] offset:4096
    v_cvt_pk_bf16_f32 v54, v44, v45
    v_mfma_f32_16x16x32_bf16 v[144:147], a[208:211], v[48:51], v[144:147]
    buffer_load_dwordx4 v2, s[4:7], s30 offen offset:2048 nt lds
    v_mfma_f32_16x16x32_bf16 v[148:151], a[212:215], v[48:51], v[148:151]
    ds_write_b64 v60, v[104:105] offset:4096
    v_mfma_f32_16x16x32_bf16 v[152:155], a[216:219], v[48:51], v[152:155]
    v_exp_f32 v46, v46
    v_exp_f32 v47, v47
    v_mfma_f32_16x16x32_bf16 v[156:159], a[220:223], v[48:51], v[156:159]
    ds_write_b64 v61, v[106:107] offset:4096
    v_cvt_pk_bf16_f32 v55, v46, v47
    v_mfma_f32_16x16x32_bf16 a[232:235], a[248:251], v[48:51], a[232:235]
    v_exp_f32 v32, v32
    v_exp_f32 v33, v33
    v_mfma_f32_16x16x32_bf16 v[40:43], a[128:131], a[80:83], v[28:31]
    ds_write_b64 v62, v[108:109] offset:4096
    v_cvt_pk_bf16_f32 v48, v32, v33
    v_mfma_f32_16x16x32_bf16 v[40:43], a[132:135], a[84:87], v[40:43]
    ds_write_b64 v63, v[110:111] offset:4096
    v_mfma_f32_16x16x32_bf16 v[40:43], a[136:139], a[88:91], v[40:43]
    v_exp_f32 v34, v34
    v_exp_f32 v35, v35
    v_mfma_f32_16x16x32_bf16 v[40:43], a[140:143], a[92:95], v[40:43]
    s_waitcnt vmcnt(4)
    s_barrier
    v_cvt_pk_bf16_f32 v49, v34, v35
    v_mfma_f32_16x16x32_bf16 v[44:47], a[144:147], a[80:83], v[28:31]
    ds_read_b128 a[96:99], v4 offset:0
    ds_read_b128 a[100:103], v5 offset:0
    v_accvgpr_read_b32 v21, a232
    v_rcp_f32 v20, v21
    v_subrev_u32 v21, s50, v21
    v_cmp_le_u32 vcc, s51, v21
    v_pk_mul_f32 v[128:129], v[128:129], v[20:21] op_sel_hi:[1,0]
    v_pk_mul_f32 v[130:131], v[130:131], v[20:21] op_sel_hi:[1,0]
    v_pk_mul_f32 v[132:133], v[132:133], v[20:21] op_sel_hi:[1,0]
    v_pk_mul_f32 v[134:135], v[134:135], v[20:21] op_sel_hi:[1,0]
    v_pk_mul_f32 v[136:137], v[136:137], v[20:21] op_sel_hi:[1,0]
    v_pk_mul_f32 v[138:139], v[138:139], v[20:21] op_sel_hi:[1,0]
    v_pk_mul_f32 v[140:141], v[140:141], v[20:21] op_sel_hi:[1,0]
    v_pk_mul_f32 v[142:143], v[142:143], v[20:21] op_sel_hi:[1,0]
    v_pk_mul_f32 v[144:145], v[144:145], v[20:21] op_sel_hi:[1,0]
    v_pk_mul_f32 v[146:147], v[146:147], v[20:21] op_sel_hi:[1,0]
    v_pk_mul_f32 v[148:149], v[148:149], v[20:21] op_sel_hi:[1,0]
    v_pk_mul_f32 v[150:151], v[150:151], v[20:21] op_sel_hi:[1,0]
    v_pk_mul_f32 v[152:153], v[152:153], v[20:21] op_sel_hi:[1,0]
    v_pk_mul_f32 v[154:155], v[154:155], v[20:21] op_sel_hi:[1,0]
    v_pk_mul_f32 v[156:157], v[156:157], v[20:21] op_sel_hi:[1,0]
    v_pk_mul_f32 v[158:159], v[158:159], v[20:21] op_sel_hi:[1,0]
    s_or_b64 s[46:47], s[46:47], vcc
    v_cvt_pk_bf16_f32 v128, v128, v129
    v_cvt_pk_bf16_f32 v129, v130, v131
    v_cvt_pk_bf16_f32 v130, v132, v133
    v_cvt_pk_bf16_f32 v131, v134, v135
    v_cvt_pk_bf16_f32 v132, v136, v137
    v_cvt_pk_bf16_f32 v133, v138, v139
    v_cvt_pk_bf16_f32 v134, v140, v141
    v_cvt_pk_bf16_f32 v135, v142, v143
    v_cvt_pk_bf16_f32 v136, v144, v145
    v_cvt_pk_bf16_f32 v137, v146, v147
    v_cvt_pk_bf16_f32 v138, v148, v149
    v_cvt_pk_bf16_f32 v139, v150, v151
    v_cvt_pk_bf16_f32 v140, v152, v153
    v_cvt_pk_bf16_f32 v141, v154, v155
    v_cvt_pk_bf16_f32 v142, v156, v157
    v_cvt_pk_bf16_f32 v143, v158, v159
    v_mfma_f32_16x16x32_bf16 v[44:47], a[148:151], a[84:87], v[44:47]
    ds_read_b128 a[104:107], v6 offset:0
    ds_read_b128 a[108:111], v7 offset:0
    v_mfma_f32_16x16x32_bf16 v[44:47], a[152:155], a[88:91], v[44:47]
    ds_read_b128 a[112:115], v4 offset:8192
    ds_read_b128 a[116:119], v5 offset:8192
    v_mfma_f32_16x16x32_bf16 v[44:47], a[156:159], a[92:95], v[44:47]
    ds_read_b128 a[120:123], v6 offset:8192
    ds_read_b128 a[124:127], v7 offset:8192
    v_mfma_f32_16x16x32_bf16 v[160:163], a[192:195], v[52:55], v[160:163]
    ds_write_b64 v56, v[128:129] offset:8192
    buffer_store_dwordx4 v[84:87], v23, s[12:15], s43 offen offset:1024 sc1
    v_mfma_f32_16x16x32_bf16 v[164:167], a[196:199], v[52:55], v[164:167]
    ds_read_b128 a[48:51], v16 offset:12288
    ds_read_b128 a[52:55], v17 offset:12288
    v_mfma_f32_16x16x32_bf16 v[168:171], a[200:203], v[52:55], v[168:171]
    ds_write_b64 v57, v[130:131] offset:8192
    v_mfma_f32_16x16x32_bf16 v[172:175], a[204:207], v[52:55], v[172:175]
    ds_write_b64 v58, v[132:133] offset:8192
    v_mfma_f32_16x16x32_bf16 v[176:179], a[208:211], v[52:55], v[176:179]
    buffer_load_dwordx4 v3, s[4:7], s30 offen offset:3072 nt lds
    v_mfma_f32_16x16x32_bf16 v[180:183], a[212:215], v[52:55], v[180:183]
    ds_write_b64 v59, v[134:135] offset:8192
    s_add_u32 m0, m0, 4096
    v_mfma_f32_16x16x32_bf16 v[184:187], a[216:219], v[52:55], v[184:187]
    ds_read_b128 a[56:59], v18 offset:12288
    ds_read_b128 a[60:63], v19 offset:12288
    v_mfma_f32_16x16x32_bf16 v[188:191], a[220:223], v[52:55], v[188:191]
    ds_write_b64 v60, v[136:137] offset:8192
    v_mfma_f32_16x16x32_bf16 a[236:239], a[248:251], v[52:55], a[236:239]
    v_exp_f32 v36, v36
    v_exp_f32 v37, v37
    s_waitcnt lgkmcnt(9)
    v_mfma_f32_16x16x32_bf16 v[32:35], a[96:99], a[0:3], 0
    ds_write_b64 v61, v[138:139] offset:8192
    v_cvt_pk_bf16_f32 v50, v36, v37
    v_mfma_f32_16x16x32_bf16 v[32:35], a[100:103], a[4:7], v[32:35]
    ds_read_b64_tr_b16 a[160:161], v8 offset:0
    v_add_u32 v16, s57, v4
    v_add_u32 v17, s57, v5
    v_mfma_f32_16x16x32_bf16 v[32:35], a[104:107], a[8:11], v[32:35]
    ds_write_b64 v62, v[140:141] offset:8192
    v_add_u32 v18, s57, v6
    v_add_u32 v19, s57, v7
    v_exp_f32 v38, v38
    v_exp_f32 v39, v39
    v_mfma_f32_16x16x32_bf16 v[32:35], a[108:111], a[12:15], v[32:35]
    ds_read_b64_tr_b16 a[162:163], v8 offset:8192
    v_cvt_pk_bf16_f32 v51, v38, v39
    v_mfma_f32_16x16x32_bf16 v[36:39], a[112:115], a[0:3], 0
    buffer_load_dwordx4 v2, s[8:11], s30 offen offset:0 nt lds
    ds_write_b64 v63, v[142:143] offset:8192
    v_mfma_f32_16x16x32_bf16 v[36:39], a[116:119], a[4:7], v[36:39]
    v_accvgpr_read_b32 v21, a236
    v_rcp_f32 v20, v21
    v_subrev_u32 v21, s50, v21
    v_cmp_le_u32 vcc, s51, v21
    v_pk_mul_f32 v[160:161], v[160:161], v[20:21] op_sel_hi:[1,0]
    v_pk_mul_f32 v[162:163], v[162:163], v[20:21] op_sel_hi:[1,0]
    v_pk_mul_f32 v[164:165], v[164:165], v[20:21] op_sel_hi:[1,0]
    v_pk_mul_f32 v[166:167], v[166:167], v[20:21] op_sel_hi:[1,0]
    v_pk_mul_f32 v[168:169], v[168:169], v[20:21] op_sel_hi:[1,0]
    v_pk_mul_f32 v[170:171], v[170:171], v[20:21] op_sel_hi:[1,0]
    v_pk_mul_f32 v[172:173], v[172:173], v[20:21] op_sel_hi:[1,0]
    v_pk_mul_f32 v[174:175], v[174:175], v[20:21] op_sel_hi:[1,0]
    v_pk_mul_f32 v[176:177], v[176:177], v[20:21] op_sel_hi:[1,0]
    v_pk_mul_f32 v[178:179], v[178:179], v[20:21] op_sel_hi:[1,0]
    v_pk_mul_f32 v[180:181], v[180:181], v[20:21] op_sel_hi:[1,0]
    v_pk_mul_f32 v[182:183], v[182:183], v[20:21] op_sel_hi:[1,0]
    v_pk_mul_f32 v[184:185], v[184:185], v[20:21] op_sel_hi:[1,0]
    v_pk_mul_f32 v[186:187], v[186:187], v[20:21] op_sel_hi:[1,0]
    v_pk_mul_f32 v[188:189], v[188:189], v[20:21] op_sel_hi:[1,0]
    v_pk_mul_f32 v[190:191], v[190:191], v[20:21] op_sel_hi:[1,0]
    s_or_b64 s[46:47], s[46:47], vcc
    v_cvt_pk_bf16_f32 v160, v160, v161
    v_cvt_pk_bf16_f32 v161, v162, v163
    v_cvt_pk_bf16_f32 v162, v164, v165
    v_cvt_pk_bf16_f32 v163, v166, v167
    v_cvt_pk_bf16_f32 v164, v168, v169
    v_cvt_pk_bf16_f32 v165, v170, v171
    v_cvt_pk_bf16_f32 v166, v172, v173
    v_cvt_pk_bf16_f32 v167, v174, v175
    v_cvt_pk_bf16_f32 v168, v176, v177
    v_cvt_pk_bf16_f32 v169, v178, v179
    v_cvt_pk_bf16_f32 v170, v180, v181
    v_cvt_pk_bf16_f32 v171, v182, v183
    v_cvt_pk_bf16_f32 v172, v184, v185
    v_cvt_pk_bf16_f32 v173, v186, v187
    v_cvt_pk_bf16_f32 v174, v188, v189
    v_cvt_pk_bf16_f32 v175, v190, v191
    v_mfma_f32_16x16x32_bf16 v[36:39], a[120:123], a[8:11], v[36:39]
    ds_write_b64 v56, v[160:161] offset:12288
    v_mfma_f32_16x16x32_bf16 v[36:39], a[124:127], a[12:15], v[36:39]
    ds_read_b64_tr_b16 a[164:165], v9 offset:0
    v_exp_f32 v40, v40
    v_exp_f32 v41, v41
    v_mfma_f32_16x16x32_bf16 v[192:195], a[192:195], v[48:51], v[192:195]
    ds_write_b64 v57, v[162:163] offset:12288
    v_cvt_pk_bf16_f32 v52, v40, v41
    v_mfma_f32_16x16x32_bf16 v[196:199], a[196:199], v[48:51], v[196:199]
    buffer_store_dwordx4 v[88:91], v22, s[12:15], s43 offen offset:2048 sc1
    v_mfma_f32_16x16x32_bf16 v[200:203], a[200:203], v[48:51], v[200:203]
    ds_write_b64 v58, v[164:165] offset:12288
    v_mfma_f32_16x16x32_bf16 v[204:207], a[204:207], v[48:51], v[204:207]
    ds_read_b64_tr_b16 a[166:167], v9 offset:8192
    v_max3_f32 v30, v32, v33, v34
    v_max3_f32 v30, v30, v35, v36
    v_mfma_f32_16x16x32_bf16 v[208:211], a[208:211], v[48:51], v[208:211]
    ds_write_b64 v59, v[166:167] offset:12288
    v_max3_f32 v30, v30, v37, v38
    v_max_f32 v30, v30, v39
    v_mfma_f32_16x16x32_bf16 v[212:215], a[212:215], v[48:51], v[212:215]
    ds_read_b64_tr_b16 a[168:169], v10 offset:0
    v_mov_b32 v31, v30
    v_mfma_f32_16x16x32_bf16 v[216:219], a[216:219], v[48:51], v[216:219]
    ds_write_b64 v60, v[168:169] offset:12288
    v_permlane32_swap_b32 v30, v31
    v_max_f32 v30, v30, v31
    v_mov_b32 v31, v30
    v_mfma_f32_16x16x32_bf16 v[220:223], a[220:223], v[48:51], v[220:223]
    buffer_load_dwordx4 v3, s[8:11], s30 offen offset:1024 nt lds
    ds_read_b64_tr_b16 a[170:171], v10 offset:8192
    v_exp_f32 v42, v42
    v_exp_f32 v43, v43
    v_permlane16_swap_b32 v30, v31
    v_max_f32 v30, v30, v31
    v_mfma_f32_16x16x32_bf16 a[240:243], a[248:251], v[48:51], a[240:243]
    ds_write_b64 v61, v[170:171] offset:12288
    v_mul_f32 v24, s38, v30
    v_cvt_pk_bf16_f32 v53, v42, v43
    v_mfma_f32_16x16x32_bf16 v[40:43], a[96:99], a[16:19], 0
    ds_read_b64_tr_b16 a[172:173], v11 offset:0
    v_exp_f32 v44, v44
    v_exp_f32 v45, v45
    v_mfma_f32_16x16x32_bf16 v[40:43], a[100:103], a[20:23], v[40:43]
    ds_write_b64 v62, v[172:173] offset:12288
    v_cvt_pk_bf16_f32 v54, v44, v45
    v_mfma_f32_16x16x32_bf16 v[40:43], a[104:107], a[24:27], v[40:43]
    ds_read_b64_tr_b16 a[174:175], v11 offset:8192
    v_exp_f32 v46, v46
    v_exp_f32 v47, v47
    v_mfma_f32_16x16x32_bf16 v[40:43], a[108:111], a[28:31], v[40:43]
    ds_write_b64 v63, v[174:175] offset:12288
    v_cvt_pk_bf16_f32 v55, v46, v47
    v_mfma_f32_16x16x32_bf16 v[44:47], a[112:115], a[16:19], 0
    v_accvgpr_read_b32 v21, a240
    v_rcp_f32 v20, v21
    v_subrev_u32 v21, s50, v21
    v_cmp_le_u32 vcc, s51, v21
    v_pk_mul_f32 v[192:193], v[192:193], v[20:21] op_sel_hi:[1,0]
    v_pk_mul_f32 v[194:195], v[194:195], v[20:21] op_sel_hi:[1,0]
    v_pk_mul_f32 v[196:197], v[196:197], v[20:21] op_sel_hi:[1,0]
    v_pk_mul_f32 v[198:199], v[198:199], v[20:21] op_sel_hi:[1,0]
    v_pk_mul_f32 v[200:201], v[200:201], v[20:21] op_sel_hi:[1,0]
    v_pk_mul_f32 v[202:203], v[202:203], v[20:21] op_sel_hi:[1,0]
    v_pk_mul_f32 v[204:205], v[204:205], v[20:21] op_sel_hi:[1,0]
    v_pk_mul_f32 v[206:207], v[206:207], v[20:21] op_sel_hi:[1,0]
    v_pk_mul_f32 v[208:209], v[208:209], v[20:21] op_sel_hi:[1,0]
    v_pk_mul_f32 v[210:211], v[210:211], v[20:21] op_sel_hi:[1,0]
    v_pk_mul_f32 v[212:213], v[212:213], v[20:21] op_sel_hi:[1,0]
    v_pk_mul_f32 v[214:215], v[214:215], v[20:21] op_sel_hi:[1,0]
    v_pk_mul_f32 v[216:217], v[216:217], v[20:21] op_sel_hi:[1,0]
    v_pk_mul_f32 v[218:219], v[218:219], v[20:21] op_sel_hi:[1,0]
    v_pk_mul_f32 v[220:221], v[220:221], v[20:21] op_sel_hi:[1,0]
    v_pk_mul_f32 v[222:223], v[222:223], v[20:21] op_sel_hi:[1,0]
    s_or_b64 s[46:47], s[46:47], vcc
    v_cvt_pk_bf16_f32 v192, v192, v193
    v_cvt_pk_bf16_f32 v193, v194, v195
    v_cvt_pk_bf16_f32 v194, v196, v197
    v_cvt_pk_bf16_f32 v195, v198, v199
    v_cvt_pk_bf16_f32 v196, v200, v201
    v_cvt_pk_bf16_f32 v197, v202, v203
    v_cvt_pk_bf16_f32 v198, v204, v205
    v_cvt_pk_bf16_f32 v199, v206, v207
    v_cvt_pk_bf16_f32 v200, v208, v209
    v_cvt_pk_bf16_f32 v201, v210, v211
    v_cvt_pk_bf16_f32 v202, v212, v213
    v_cvt_pk_bf16_f32 v203, v214, v215
    v_cvt_pk_bf16_f32 v204, v216, v217
    v_cvt_pk_bf16_f32 v205, v218, v219
    v_cvt_pk_bf16_f32 v206, v220, v221
    v_cvt_pk_bf16_f32 v207, v222, v223
    v_mfma_f32_16x16x32_bf16 v[44:47], a[116:119], a[20:23], v[44:47]
    ds_write_b64 v56, v[192:193] offset:0
    v_mfma_f32_16x16x32_bf16 v[44:47], a[120:123], a[24:27], v[44:47]
    ds_read_b64_tr_b16 a[176:177], v12 offset:0
    v_fma_f32 v32, v32, s38, -v24
    v_fma_f32 v33, v33, s38, -v24
    v_mfma_f32_16x16x32_bf16 v[44:47], a[124:127], a[28:31], v[44:47]
    ds_write_b64 v57, v[194:195] offset:0
    v_exp_f32 v32, v32
    v_exp_f32 v33, v33
    v_mfma_f32_16x16x32_bf16 v[224:227], a[192:195], v[52:55], v[224:227]
    buffer_store_dwordx4 v[92:95], v23, s[12:15], s43 offen offset:3072 sc1
    v_cvt_pk_bf16_f32 v48, v32, v33
    v_mfma_f32_16x16x32_bf16 v[228:231], a[196:199], v[52:55], v[228:231]
    ds_write_b64 v58, v[196:197] offset:0
    v_mfma_f32_16x16x32_bf16 v[232:235], a[200:203], v[52:55], v[232:235]
    ds_read_b64_tr_b16 a[178:179], v12 offset:8192
    v_fma_f32 v34, v34, s38, -v24
    v_fma_f32 v35, v35, s38, -v24
    v_mfma_f32_16x16x32_bf16 v[236:239], a[204:207], v[52:55], v[236:239]
    ds_write_b64 v59, v[198:199] offset:0
    v_max3_f32 v30, v40, v41, v42
    v_max3_f32 v30, v30, v43, v44
    v_exp_f32 v34, v34
    v_exp_f32 v35, v35
    v_mfma_f32_16x16x32_bf16 v[240:243], a[208:211], v[52:55], v[240:243]
    buffer_load_dwordx4 v2, s[8:11], s30 offen offset:2048 nt lds
    ds_read_b64_tr_b16 a[180:181], v13 offset:0
    v_max3_f32 v30, v30, v45, v46
    v_max_f32 v30, v30, v47
    v_cvt_pk_bf16_f32 v49, v34, v35
    v_mfma_f32_16x16x32_bf16 v[244:247], a[212:215], v[52:55], v[244:247]
    ds_write_b64 v60, v[200:201] offset:0
    v_mov_b32 v31, v30
    v_mfma_f32_16x16x32_bf16 v[248:251], a[216:219], v[52:55], v[248:251]
    ds_read_b64_tr_b16 a[182:183], v13 offset:8192
    v_permlane32_swap_b32 v30, v31
    v_max_f32 v30, v30, v31
    v_mov_b32 v31, v30
    v_mfma_f32_16x16x32_bf16 v[252:255], a[220:223], v[52:55], v[252:255]
    ds_write_b64 v61, v[202:203] offset:0
    v_permlane16_swap_b32 v30, v31
    v_max_f32 v30, v30, v31
    v_mfma_f32_16x16x32_bf16 a[244:247], a[248:251], v[52:55], a[244:247]
    ds_read_b64_tr_b16 a[184:185], v14 offset:0
    v_mul_f32 v25, s38, v30
    v_mfma_f32_16x16x32_bf16 v[32:35], a[96:99], a[32:35], 0
    ds_write_b64 v62, v[204:205] offset:0
    v_fma_f32 v36, v36, s38, -v24
    v_fma_f32 v37, v37, s38, -v24
    v_mfma_f32_16x16x32_bf16 v[32:35], a[100:103], a[36:39], v[32:35]
    ds_read_b64_tr_b16 a[186:187], v14 offset:8192
    ds_read_b64_tr_b16 a[188:189], v15 offset:0
    v_fma_f32 v38, v38, s38, -v24
    v_fma_f32 v39, v39, s38, -v24
    v_exp_f32 v36, v36
    v_exp_f32 v37, v37
    v_mfma_f32_16x16x32_bf16 v[32:35], a[104:107], a[40:43], v[32:35]
    ds_read_b64_tr_b16 a[190:191], v15 offset:8192
    ds_write_b64 v63, v[206:207] offset:0
    v_cvt_pk_bf16_f32 v50, v36, v37
    v_exp_f32 v38, v38
    v_exp_f32 v39, v39
    v_mfma_f32_16x16x32_bf16 v[32:35], a[108:111], a[44:47], v[32:35]
    ds_read_b128 v[208:211], v1 offset:4096
    ds_read_b128 v[212:215], v1 offset:5120
    v_cvt_pk_bf16_f32 v51, v38, v39
    v_mfma_f32_16x16x32_bf16 v[36:39], a[112:115], a[32:35], 0
    ds_read_b128 v[216:219], v1 offset:6144
    ds_read_b128 v[220:223], v1 offset:7168
    v_accvgpr_read_b32 v21, a244
    v_rcp_f32 v20, v21
    v_subrev_u32 v21, s50, v21
    v_cmp_le_u32 vcc, s51, v21
    v_pk_mul_f32 v[224:225], v[224:225], v[20:21] op_sel_hi:[1,0]
    v_pk_mul_f32 v[226:227], v[226:227], v[20:21] op_sel_hi:[1,0]
    v_pk_mul_f32 v[228:229], v[228:229], v[20:21] op_sel_hi:[1,0]
    v_pk_mul_f32 v[230:231], v[230:231], v[20:21] op_sel_hi:[1,0]
    v_pk_mul_f32 v[232:233], v[232:233], v[20:21] op_sel_hi:[1,0]
    v_pk_mul_f32 v[234:235], v[234:235], v[20:21] op_sel_hi:[1,0]
    v_pk_mul_f32 v[236:237], v[236:237], v[20:21] op_sel_hi:[1,0]
    v_pk_mul_f32 v[238:239], v[238:239], v[20:21] op_sel_hi:[1,0]
    v_pk_mul_f32 v[240:241], v[240:241], v[20:21] op_sel_hi:[1,0]
    v_pk_mul_f32 v[242:243], v[242:243], v[20:21] op_sel_hi:[1,0]
    v_pk_mul_f32 v[244:245], v[244:245], v[20:21] op_sel_hi:[1,0]
    v_pk_mul_f32 v[246:247], v[246:247], v[20:21] op_sel_hi:[1,0]
    v_pk_mul_f32 v[248:249], v[248:249], v[20:21] op_sel_hi:[1,0]
    v_pk_mul_f32 v[250:251], v[250:251], v[20:21] op_sel_hi:[1,0]
    v_pk_mul_f32 v[252:253], v[252:253], v[20:21] op_sel_hi:[1,0]
    v_pk_mul_f32 v[254:255], v[254:255], v[20:21] op_sel_hi:[1,0]
    s_or_b64 s[46:47], s[46:47], vcc
    v_cvt_pk_bf16_f32 v224, v224, v225
    v_cvt_pk_bf16_f32 v225, v226, v227
    v_cvt_pk_bf16_f32 v226, v228, v229
    v_cvt_pk_bf16_f32 v227, v230, v231
    v_cvt_pk_bf16_f32 v228, v232, v233
    v_cvt_pk_bf16_f32 v229, v234, v235
    v_cvt_pk_bf16_f32 v230, v236, v237
    v_cvt_pk_bf16_f32 v231, v238, v239
    v_cvt_pk_bf16_f32 v232, v240, v241
    v_cvt_pk_bf16_f32 v233, v242, v243
    v_cvt_pk_bf16_f32 v234, v244, v245
    v_cvt_pk_bf16_f32 v235, v246, v247
    v_cvt_pk_bf16_f32 v236, v248, v249
    v_cvt_pk_bf16_f32 v237, v250, v251
    v_cvt_pk_bf16_f32 v238, v252, v253
    v_cvt_pk_bf16_f32 v239, v254, v255
    v_mfma_f32_16x16x32_bf16 v[36:39], a[116:119], a[36:39], v[36:39]
    ds_write_b64 v56, v[224:225] offset:4096
    v_mfma_f32_16x16x32_bf16 v[36:39], a[120:123], a[40:43], v[36:39]
    ds_read_b128 a[64:67], v16 offset:0
    ds_read_b128 a[68:71], v17 offset:0
    v_mfma_f32_16x16x32_bf16 v[36:39], a[124:127], a[44:47], v[36:39]
    ds_write_b64 v57, v[226:227] offset:4096
    s_waitcnt lgkmcnt(9)
    v_mfma_f32_16x16x32_bf16 v[64:67], a[160:163], v[48:51], 0
    s_add_u32 s43, s40, 4096
    s_waitcnt lgkmcnt(4)
    buffer_store_dwordx4 v[208:211], v22, s[12:15], s43 offen offset:0 sc1
    v_mfma_f32_16x16x32_bf16 v[68:71], a[164:167], v[48:51], 0
    ds_write_b64 v58, v[228:229] offset:4096
    v_mfma_f32_16x16x32_bf16 v[72:75], a[168:171], v[48:51], 0
    ds_read_b128 a[72:75], v18 offset:0
    ds_read_b128 a[76:79], v19 offset:0
    v_mfma_f32_16x16x32_bf16 v[76:79], a[172:175], v[48:51], 0
    ds_write_b64 v59, v[230:231] offset:4096
    v_max3_f32 v30, v32, v33, v34
    v_max3_f32 v30, v30, v35, v36
    v_mfma_f32_16x16x32_bf16 v[80:83], a[176:179], v[48:51], 0
    ds_read_b128 a[80:83], v16 offset:4096
    ds_read_b128 a[84:87], v17 offset:4096
    v_max3_f32 v30, v30, v37, v38
    v_max_f32 v30, v30, v39
    v_mfma_f32_16x16x32_bf16 v[84:87], a[180:183], v[48:51], 0
    ds_write_b64 v60, v[232:233] offset:4096
    v_mov_b32 v31, v30
    v_fma_f32 v40, v40, s38, -v25
    v_fma_f32 v41, v41, s38, -v25
    v_mfma_f32_16x16x32_bf16 v[88:91], a[184:187], v[48:51], 0
    ds_read_b128 a[88:91], v18 offset:4096
    ds_read_b128 a[92:95], v19 offset:4096
    v_fma_f32 v42, v42, s38, -v25
    v_fma_f32 v43, v43, s38, -v25
    v_exp_f32 v40, v40
    v_exp_f32 v41, v41
    v_permlane32_swap_b32 v30, v31
    v_max_f32 v30, v30, v31
    v_mov_b32 v31, v30
    v_mfma_f32_16x16x32_bf16 v[92:95], a[188:191], v[48:51], 0
    ds_write_b64 v61, v[234:235] offset:4096
    v_cvt_pk_bf16_f32 v52, v40, v41
    v_exp_f32 v42, v42
    v_exp_f32 v43, v43
    v_permlane16_swap_b32 v30, v31
    v_max_f32 v30, v30, v31
    v_mfma_f32_16x16x32_bf16 a[224:227], a[248:251], v[48:51], 0
    buffer_load_dwordx4 v3, s[8:11], s30 offen offset:3072 nt lds
    v_mul_f32 v26, s38, v30
    v_cvt_pk_bf16_f32 v53, v42, v43
    v_mfma_f32_16x16x32_bf16 v[40:43], a[96:99], a[48:51], 0
    ds_write_b64 v62, v[236:237] offset:4096
    s_add_u32 s30, s30, 16384
    s_cmp_lg_u64 s[46:47], 0
    s_cselect_b32 s39, 1, 0
    s_or_b32 s48, s48, s39
    v_fma_f32 v44, v44, s38, -v25
    v_fma_f32 v45, v45, s38, -v25
    v_mfma_f32_16x16x32_bf16 v[40:43], a[100:103], a[52:55], v[40:43]
    ds_read_b128 a[128:131], v4 offset:16384
    v_fma_f32 v46, v46, s38, -v25
    v_fma_f32 v47, v47, s38, -v25
    v_exp_f32 v44, v44
    v_exp_f32 v45, v45
    v_mfma_f32_16x16x32_bf16 v[40:43], a[104:107], a[56:59], v[40:43]
    ds_write_b64 v63, v[238:239] offset:4096
    v_cvt_pk_bf16_f32 v54, v44, v45
    v_exp_f32 v46, v46
    v_exp_f32 v47, v47
    v_mfma_f32_16x16x32_bf16 v[40:43], a[108:111], a[60:63], v[40:43]
    ds_read_b128 a[132:135], v5 offset:16384
    v_cvt_pk_bf16_f32 v55, v46, v47
    v_mfma_f32_16x16x32_bf16 v[44:47], a[112:115], a[48:51], 0
    ds_read_b128 a[136:139], v6 offset:16384
    v_fma_f32 v32, v32, s38, -v26
    v_fma_f32 v33, v33, s38, -v26
    v_mfma_f32_16x16x32_bf16 v[44:47], a[116:119], a[52:55], v[44:47]
    ds_read_b128 a[140:143], v7 offset:16384
    v_exp_f32 v32, v32
    v_exp_f32 v33, v33
    v_mfma_f32_16x16x32_bf16 v[44:47], a[120:123], a[56:59], v[44:47]
    ds_read_b128 a[144:147], v4 offset:24576
    v_cvt_pk_bf16_f32 v48, v32, v33
    v_mfma_f32_16x16x32_bf16 v[44:47], a[124:127], a[60:63], v[44:47]
    ds_read_b128 a[148:151], v5 offset:24576
    v_fma_f32 v34, v34, s38, -v26
    v_fma_f32 v35, v35, s38, -v26
    v_mfma_f32_16x16x32_bf16 v[96:99], a[160:163], v[52:55], 0
    ds_read_b128 a[152:155], v6 offset:24576
    v_exp_f32 v34, v34
    v_exp_f32 v35, v35
    v_mfma_f32_16x16x32_bf16 v[100:103], a[164:167], v[52:55], 0
    ds_read_b128 a[156:159], v7 offset:24576
    v_cvt_pk_bf16_f32 v49, v34, v35
    v_mfma_f32_16x16x32_bf16 v[104:107], a[168:171], v[52:55], 0
    buffer_store_dwordx4 v[212:215], v23, s[12:15], s43 offen offset:1024 sc1
    v_mfma_f32_16x16x32_bf16 v[108:111], a[172:175], v[52:55], 0
    v_max3_f32 v30, v40, v41, v42
    v_max3_f32 v30, v30, v43, v44
    s_mov_b32 m0, s57
    s_add_u32 s96, s40, 8192
    v_mfma_f32_16x16x32_bf16 v[112:115], a[176:179], v[52:55], 0
    ds_read_b64_tr_b16 a[192:193], v8 offset:16384
    v_max3_f32 v30, v30, v45, v46
    v_max_f32 v30, v30, v47
    v_mfma_f32_16x16x32_bf16 v[116:119], a[180:183], v[52:55], 0
    v_mov_b32 v31, v30
    v_fma_f32 v36, v36, s38, -v26
    v_fma_f32 v37, v37, s38, -v26
    v_mfma_f32_16x16x32_bf16 v[120:123], a[184:187], v[52:55], 0
    v_exp_f32 v36, v36
    v_exp_f32 v37, v37
    v_permlane32_swap_b32 v30, v31
    v_max_f32 v30, v30, v31
    v_mov_b32 v31, v30
    v_mfma_f32_16x16x32_bf16 v[124:127], a[188:191], v[52:55], 0
    v_cvt_pk_bf16_f32 v50, v36, v37
    v_permlane16_swap_b32 v30, v31
    v_max_f32 v30, v30, v31
    v_mfma_f32_16x16x32_bf16 a[228:231], a[248:251], v[52:55], 0
    v_mul_f32 v27, s38, v30
    s_waitcnt lgkmcnt(12)
    v_mfma_f32_16x16x32_bf16 v[32:35], a[96:99], a[64:67], 0
    ds_read_b64_tr_b16 a[194:195], v8 offset:24576
    v_fma_f32 v38, v38, s38, -v26
    v_mfma_f32_16x16x32_bf16 v[32:35], a[100:103], a[68:71], v[32:35]
    buffer_load_dwordx4 v2, s[4:7], s30 offen offset:0 nt lds
    v_fma_f32 v39, v39, s38, -v26
    v_mfma_f32_16x16x32_bf16 v[32:35], a[104:107], a[72:75], v[32:35]
    v_exp_f32 v38, v38
    v_exp_f32 v39, v39
    v_mfma_f32_16x16x32_bf16 v[32:35], a[108:111], a[76:79], v[32:35]
    v_cvt_pk_bf16_f32 v51, v38, v39
    v_fma_f32 v40, v40, s38, -v27
    v_fma_f32 v41, v41, s38, -v27
    v_mfma_f32_16x16x32_bf16 v[36:39], a[112:115], a[64:67], 0
    buffer_load_dwordx4 v3, s[4:7], s30 offen offset:1024 nt lds
    v_exp_f32 v40, v40
    v_exp_f32 v41, v41
    v_mfma_f32_16x16x32_bf16 v[36:39], a[116:119], a[68:71], v[36:39]
    ds_read_b64_tr_b16 a[196:197], v9 offset:16384
    v_cvt_pk_bf16_f32 v52, v40, v41
    v_mfma_f32_16x16x32_bf16 v[36:39], a[120:123], a[72:75], v[36:39]
    v_fma_f32 v42, v42, s38, -v27
    v_fma_f32 v43, v43, s38, -v27
    v_mfma_f32_16x16x32_bf16 v[36:39], a[124:127], a[76:79], v[36:39]
    buffer_store_dwordx4 v[216:219], v22, s[12:15], s43 offen offset:2048 sc1
    v_exp_f32 v42, v42
    v_exp_f32 v43, v43
    v_mfma_f32_16x16x32_bf16 v[128:131], a[160:163], v[48:51], 0
    ds_read_b64_tr_b16 a[198:199], v9 offset:24576
    v_cvt_pk_bf16_f32 v53, v42, v43
    v_mfma_f32_16x16x32_bf16 v[132:135], a[164:167], v[48:51], 0
    buffer_load_dwordx4 v2, s[4:7], s30 offen offset:2048 nt lds
    v_mfma_f32_16x16x32_bf16 v[136:139], a[168:171], v[48:51], 0
    v_fma_f32 v44, v44, s38, -v27
    v_fma_f32 v45, v45, s38, -v27
    v_mfma_f32_16x16x32_bf16 v[140:143], a[172:175], v[48:51], 0
    ds_read_b64_tr_b16 a[200:201], v10 offset:16384
    v_max3_f32 v30, v32, v33, v34
    v_max3_f32 v30, v30, v35, v36
    v_exp_f32 v44, v44
    v_exp_f32 v45, v45
    v_mfma_f32_16x16x32_bf16 v[144:147], a[176:179], v[48:51], 0
    v_max3_f32 v30, v30, v37, v38
    v_max_f32 v30, v30, v39
    v_cvt_pk_bf16_f32 v54, v44, v45
    v_mfma_f32_16x16x32_bf16 v[148:151], a[180:183], v[48:51], 0
    v_mov_b32 v31, v30
    v_add_u32 v1, 8192, v1
    v_mfma_f32_16x16x32_bf16 v[152:155], a[184:187], v[48:51], 0
    buffer_load_dwordx4 v3, s[4:7], s30 offen offset:3072 nt lds
    v_permlane32_swap_b32 v30, v31
    v_max_f32 v30, v30, v31
    v_mov_b32 v31, v30
    v_mfma_f32_16x16x32_bf16 v[156:159], a[188:191], v[48:51], 0
    s_add_u32 m0, m0, 4096
    v_permlane16_swap_b32 v30, v31
    v_max_f32 v30, v30, v31
    v_mfma_f32_16x16x32_bf16 a[232:235], a[248:251], v[48:51], 0
    v_mul_f32 v28, s38, v30
    v_fma_f32 v46, v46, s38, -v27
    v_mfma_f32_16x16x32_bf16 v[40:43], a[96:99], a[80:83], 0
    ds_read_b64_tr_b16 a[202:203], v10 offset:24576
    v_exp_f32 v46, v46
    v_mfma_f32_16x16x32_bf16 v[40:43], a[100:103], a[84:87], v[40:43]
    buffer_load_dwordx4 v2, s[8:11], s30 offen offset:0 nt lds
    v_fma_f32 v47, v47, s38, -v27
    v_mfma_f32_16x16x32_bf16 v[40:43], a[104:107], a[88:91], v[40:43]
    v_exp_f32 v47, v47
    v_mfma_f32_16x16x32_bf16 v[40:43], a[108:111], a[92:95], v[40:43]
    ds_read_b64_tr_b16 a[204:205], v11 offset:16384
    v_cvt_pk_bf16_f32 v55, v46, v47
    v_mfma_f32_16x16x32_bf16 v[44:47], a[112:115], a[80:83], 0
    v_fma_f32 v32, v32, s38, -v28
    v_fma_f32 v33, v33, s38, -v28
    v_mfma_f32_16x16x32_bf16 v[44:47], a[116:119], a[84:87], v[44:47]
    buffer_load_dwordx4 v3, s[8:11], s30 offen offset:1024 nt lds
    v_exp_f32 v32, v32
    v_exp_f32 v33, v33
    v_mfma_f32_16x16x32_bf16 v[44:47], a[120:123], a[88:91], v[44:47]
    ds_read_b64_tr_b16 a[206:207], v11 offset:24576
    v_cvt_pk_bf16_f32 v48, v32, v33
    v_mfma_f32_16x16x32_bf16 v[44:47], a[124:127], a[92:95], v[44:47]
    v_fma_f32 v34, v34, s38, -v28
    v_fma_f32 v35, v35, s38, -v28
    v_mfma_f32_16x16x32_bf16 v[160:163], a[160:163], v[52:55], 0
    buffer_store_dwordx4 v[220:223], v23, s[12:15], s43 offen offset:3072 sc1
    v_mfma_f32_16x16x32_bf16 v[164:167], a[164:167], v[52:55], 0
    v_exp_f32 v34, v34
    v_exp_f32 v35, v35
    v_mfma_f32_16x16x32_bf16 v[168:171], a[168:171], v[52:55], 0
    buffer_load_dwordx4 v2, s[8:11], s30 offen offset:2048 nt lds
    v_cvt_pk_bf16_f32 v49, v34, v35
    v_mfma_f32_16x16x32_bf16 v[172:175], a[172:175], v[52:55], 0
    v_max3_f32 v30, v40, v41, v42
    v_max3_f32 v30, v30, v43, v44
    v_mfma_f32_16x16x32_bf16 v[176:179], a[176:179], v[52:55], 0
    v_max3_f32 v30, v30, v45, v46
    v_max_f32 v30, v30, v47
    v_mfma_f32_16x16x32_bf16 v[180:183], a[180:183], v[52:55], 0
    v_mov_b32 v31, v30
    v_fma_f32 v36, v36, s38, -v28
    v_fma_f32 v37, v37, s38, -v28
    v_mfma_f32_16x16x32_bf16 v[184:187], a[184:187], v[52:55], 0
    v_exp_f32 v36, v36
    v_exp_f32 v37, v37
    v_permlane32_swap_b32 v30, v31
    v_max_f32 v30, v30, v31
    v_mov_b32 v31, v30
    v_mfma_f32_16x16x32_bf16 v[188:191], a[188:191], v[52:55], 0
    v_cvt_pk_bf16_f32 v50, v36, v37
    v_permlane16_swap_b32 v30, v31
    v_max_f32 v30, v30, v31
    v_mfma_f32_16x16x32_bf16 a[236:239], a[248:251], v[52:55], 0
    v_mul_f32 v29, s38, v30
    s_waitcnt lgkmcnt(8)
    v_mfma_f32_16x16x32_bf16 v[32:35], a[128:131], a[0:3], 0
    ds_read_b64_tr_b16 a[208:209], v12 offset:16384
    v_fma_f32 v38, v38, s38, -v28
    v_mfma_f32_16x16x32_bf16 v[32:35], a[132:135], a[4:7], v[32:35]
    buffer_load_dwordx4 v3, s[8:11], s30 offen offset:3072 nt lds
    v_fma_f32 v39, v39, s38, -v28
    v_mfma_f32_16x16x32_bf16 v[32:35], a[136:139], a[8:11], v[32:35]
    v_exp_f32 v38, v38
    v_exp_f32 v39, v39
    v_mfma_f32_16x16x32_bf16 v[32:35], a[140:143], a[12:15], v[32:35]
    ds_read_b64_tr_b16 a[210:211], v12 offset:24576
    v_cvt_pk_bf16_f32 v51, v38, v39
    v_mfma_f32_16x16x32_bf16 v[36:39], a[144:147], a[0:3], 0
    v_add_u32 v4, 32768, v4
    v_fma_f32 v40, v40, s38, -v29
    v_mfma_f32_16x16x32_bf16 v[36:39], a[148:151], a[4:7], v[36:39]
    v_exp_f32 v40, v40
    v_mfma_f32_16x16x32_bf16 v[36:39], a[152:155], a[8:11], v[36:39]
    ds_read_b64_tr_b16 a[212:213], v13 offset:16384
    v_fma_f32 v41, v41, s38, -v29
    v_mfma_f32_16x16x32_bf16 v[36:39], a[156:159], a[12:15], v[36:39]
    v_add_u32 v5, 32768, v5
    v_exp_f32 v41, v41
    v_mfma_f32_16x16x32_bf16 v[192:195], a[160:163], v[48:51], 0
    v_cvt_pk_bf16_f32 v52, v40, v41
    v_fma_f32 v42, v42, s38, -v29
    v_mfma_f32_16x16x32_bf16 v[196:199], a[164:167], v[48:51], 0
    ds_read_b64_tr_b16 a[214:215], v13 offset:24576
    v_exp_f32 v42, v42
    v_mfma_f32_16x16x32_bf16 v[200:203], a[168:171], v[48:51], 0
    v_add_u32 v6, 32768, v6
    v_fma_f32 v43, v43, s38, -v29
    v_mfma_f32_16x16x32_bf16 v[204:207], a[172:175], v[48:51], 0
    v_exp_f32 v43, v43
    v_mfma_f32_16x16x32_bf16 v[208:211], a[176:179], v[48:51], 0
    ds_read_b64_tr_b16 a[216:217], v14 offset:16384
    v_cvt_pk_bf16_f32 v53, v42, v43
    v_mfma_f32_16x16x32_bf16 v[212:215], a[180:183], v[48:51], 0
    v_add_u32 v7, 32768, v7
    v_fma_f32 v44, v44, s38, -v29
    v_mfma_f32_16x16x32_bf16 v[216:219], a[184:187], v[48:51], 0
    v_fma_f32 v45, v45, s38, -v29
    v_exp_f32 v44, v44
    v_mfma_f32_16x16x32_bf16 v[220:223], a[188:191], v[48:51], 0
    v_exp_f32 v45, v45
    v_mfma_f32_16x16x32_bf16 a[240:243], a[248:251], v[48:51], 0
    s_mov_b32 s35, 0
    s_mov_b32 s99, s29
    v_cvt_pk_bf16_f32 v54, v44, v45
    v_mfma_f32_16x16x32_bf16 v[40:43], a[128:131], a[16:19], 0
    ds_read_b64_tr_b16 a[218:219], v14 offset:24576
    v_fma_f32 v46, v46, s38, -v29
    v_mfma_f32_16x16x32_bf16 v[40:43], a[132:135], a[20:23], v[40:43]
    v_fma_f32 v47, v47, s38, -v29
    v_exp_f32 v46, v46
    v_mfma_f32_16x16x32_bf16 v[40:43], a[136:139], a[24:27], v[40:43]
    v_exp_f32 v47, v47
    v_mfma_f32_16x16x32_bf16 v[40:43], a[140:143], a[28:31], v[40:43]
    ds_read_b64_tr_b16 a[220:221], v15 offset:16384
    v_cvt_pk_bf16_f32 v55, v46, v47
    v_mfma_f32_16x16x32_bf16 v[44:47], a[144:147], a[16:19], 0
    v_fma_f32 v32, v32, s38, -v24
    v_fma_f32 v33, v33, s38, -v24
    v_mfma_f32_16x16x32_bf16 v[44:47], a[148:151], a[20:23], v[44:47]
    v_exp_f32 v32, v32
    v_mfma_f32_16x16x32_bf16 v[44:47], a[152:155], a[24:27], v[44:47]
    ds_read_b64_tr_b16 a[222:223], v15 offset:24576
    v_exp_f32 v33, v33
    v_mfma_f32_16x16x32_bf16 v[44:47], a[156:159], a[28:31], v[44:47]
    v_cvt_pk_bf16_f32 v48, v32, v33
    v_fma_f32 v34, v34, s38, -v24
    v_mfma_f32_16x16x32_bf16 v[224:227], a[160:163], v[52:55], 0
    v_exp_f32 v34, v34
    v_mfma_f32_16x16x32_bf16 v[228:231], a[164:167], v[52:55], 0
    s_add_u32 s30, s30, 16384
    s_add_u32 s40, s40, 98304
    v_fma_f32 v35, v35, s38, -v24
    v_mfma_f32_16x16x32_bf16 v[232:235], a[168:171], v[52:55], 0
    v_exp_f32 v35, v35
    v_mfma_f32_16x16x32_bf16 v[236:239], a[172:175], v[52:55], 0
    s_mov_b32 s34, 32768
    v_cvt_pk_bf16_f32 v49, v34, v35
    v_mfma_f32_16x16x32_bf16 v[240:243], a[176:179], v[52:55], 0
    v_fma_f32 v36, v36, s38, -v24
    v_fma_f32 v37, v37, s38, -v24
    v_mfma_f32_16x16x32_bf16 v[244:247], a[180:183], v[52:55], 0
    v_exp_f32 v36, v36
    v_mfma_f32_16x16x32_bf16 v[248:251], a[184:187], v[52:55], 0
    s_waitcnt vmcnt(11) lgkmcnt(0)
    s_barrier
    v_fma_f32 v38, v38, s38, -v24
    v_fma_f32 v39, v39, s38, -v24
    v_exp_f32 v37, v37
    v_mfma_f32_16x16x32_bf16 v[252:255], a[188:191], v[52:55], 0
    v_exp_f32 v38, v38
    v_exp_f32 v39, v39
    v_mfma_f32_16x16x32_bf16 a[244:247], a[248:251], v[52:55], 0
    v_cvt_pk_bf16_f32 v50, v36, v37
    v_cvt_pk_bf16_f32 v51, v38, v39
L_loopB:
    v_mfma_f32_16x16x32_bf16 v[32:35], a[128:131], a[32:35], 0
    s_mov_b32 m0, s99
    s_add_u32 s99, s99, s34
    v_mfma_f32_16x16x32_bf16 v[32:35], a[132:135], a[36:39], v[32:35]
    ds_read_b128 a[96:99], v4 offset:0
    v_add_u32 v8, s34, v8
    v_mfma_f32_16x16x32_bf16 v[32:35], a[136:139], a[40:43], v[32:35]
    v_fma_f32 v40, v40, s38, -v25
    v_fma_f32 v41, v41, s38, -v25
    v_mfma_f32_16x16x32_bf16 v[32:35], a[140:143], a[44:47], v[32:35]
    buffer_load_dwordx4 v2, s[4:7], s30 offen offset:0 nt lds
    v_mfma_f32_16x16x32_bf16 v[36:39], a[144:147], a[32:35], 0
    v_exp_f32 v40, v40
    v_mfma_f32_16x16x32_bf16 v[36:39], a[148:151], a[36:39], v[36:39]
    ds_read_b128 a[100:103], v5 offset:0
    v_add_u32 v9, s34, v9
    v_mfma_f32_16x16x32_bf16 v[36:39], a[152:155], a[40:43], v[36:39]
    v_exp_f32 v41, v41
    v_mfma_f32_16x16x32_bf16 v[36:39], a[156:159], a[44:47], v[36:39]
    v_cvt_pk_bf16_f32 v52, v40, v41
    v_fma_f32 v42, v42, s38, -v25
    v_mfma_f32_16x16x32_bf16 v[64:67], a[192:195], v[48:51], v[64:67]
    v_exp_f32 v42, v42
    v_mfma_f32_16x16x32_bf16 v[68:71], a[196:199], v[48:51], v[68:71]
    ds_read_b128 a[104:107], v6 offset:0
    v_add_u32 v10, s34, v10
    v_fma_f32 v43, v43, s38, -v25
    v_mfma_f32_16x16x32_bf16 v[72:75], a[200:203], v[48:51], v[72:75]
    v_exp_f32 v43, v43
    v_mfma_f32_16x16x32_bf16 v[76:79], a[204:207], v[48:51], v[76:79]
    buffer_load_dwordx4 v3, s[4:7], s30 offen offset:1024 nt lds
    v_mfma_f32_16x16x32_bf16 v[80:83], a[208:211], v[48:51], v[80:83]
    v_cvt_pk_bf16_f32 v53, v42, v43
    v_fma_f32 v44, v44, s38, -v25
    v_mfma_f32_16x16x32_bf16 v[84:87], a[212:215], v[48:51], v[84:87]
    ds_read_b128 a[108:111], v7 offset:0
    v_add_u32 v11, s34, v11
    v_mfma_f32_16x16x32_bf16 v[88:91], a[216:219], v[48:51], v[88:91]
    v_fma_f32 v45, v45, s38, -v25
    v_exp_f32 v44, v44
    v_mfma_f32_16x16x32_bf16 v[92:95], a[220:223], v[48:51], v[92:95]
    v_exp_f32 v45, v45
    v_mfma_f32_16x16x32_bf16 a[224:227], a[248:251], v[48:51], a[224:227]
    v_cvt_pk_bf16_f32 v54, v44, v45
    v_fma_f32 v46, v46, s38, -v25
    v_mfma_f32_16x16x32_bf16 v[40:43], a[128:131], a[48:51], 0
    v_exp_f32 v46, v46
    v_mfma_f32_16x16x32_bf16 v[40:43], a[132:135], a[52:55], v[40:43]
    ds_read_b128 a[112:115], v4 offset:8192
    v_add_u32 v12, s34, v12
    v_fma_f32 v47, v47, s38, -v25
    v_mfma_f32_16x16x32_bf16 v[40:43], a[136:139], a[56:59], v[40:43]
    v_exp_f32 v47, v47
    v_mfma_f32_16x16x32_bf16 v[40:43], a[140:143], a[60:63], v[40:43]
    buffer_load_dwordx4 v2, s[4:7], s30 offen offset:2048 nt lds
    v_cvt_pk_bf16_f32 v55, v46, v47
    v_mfma_f32_16x16x32_bf16 v[44:47], a[144:147], a[48:51], 0
    v_fma_f32 v32, v32, s38, -v26
    v_fma_f32 v33, v33, s38, -v26
    v_mfma_f32_16x16x32_bf16 v[44:47], a[148:151], a[52:55], v[44:47]
    ds_read_b128 a[116:119], v5 offset:8192
    v_add_u32 v13, s34, v13
    v_mfma_f32_16x16x32_bf16 v[44:47], a[152:155], a[56:59], v[44:47]
    v_exp_f32 v32, v32
    v_mfma_f32_16x16x32_bf16 v[44:47], a[156:159], a[60:63], v[44:47]
    v_exp_f32 v33, v33
    v_mfma_f32_16x16x32_bf16 v[96:99], a[192:195], v[52:55], v[96:99]
    v_cvt_pk_bf16_f32 v48, v32, v33
    v_fma_f32 v34, v34, s38, -v26
    v_mfma_f32_16x16x32_bf16 v[100:103], a[196:199], v[52:55], v[100:103]
    ds_read_b128 a[120:123], v6 offset:8192
    v_add_u32 v14, s34, v14
    v_mfma_f32_16x16x32_bf16 v[104:107], a[200:203], v[52:55], v[104:107]
    v_exp_f32 v34, v34
    v_mfma_f32_16x16x32_bf16 v[108:111], a[204:207], v[52:55], v[108:111]
    buffer_load_dwordx4 v3, s[4:7], s30 offen offset:3072 nt lds
    v_fma_f32 v35, v35, s38, -v26
    v_mfma_f32_16x16x32_bf16 v[112:115], a[208:211], v[52:55], v[112:115]
    v_exp_f32 v35, v35
    v_mfma_f32_16x16x32_bf16 v[116:119], a[212:215], v[52:55], v[116:119]
    ds_read_b128 a[124:127], v7 offset:8192
    v_add_u32 v15, s34, v15
    v_cvt_pk_bf16_f32 v49, v34, v35
    v_mfma_f32_16x16x32_bf16 v[120:123], a[216:219], v[52:55], v[120:123]
    v_fma_f32 v36, v36, s38, -v26
    v_fma_f32 v37, v37, s38, -v26
    v_mfma_f32_16x16x32_bf16 v[124:127], a[220:223], v[52:55], v[124:127]
    v_exp_f32 v36, v36
    v_exp_f32 v37, v37
    v_mfma_f32_16x16x32_bf16 a[228:231], a[248:251], v[52:55], a[228:231]
    v_cvt_pk_bf16_f32 v50, v36, v37
    v_fma_f32 v38, v38, s38, -v26
    v_mfma_f32_16x16x32_bf16 v[32:35], a[128:131], a[64:67], 0
    v_exp_f32 v38, v38
    v_mfma_f32_16x16x32_bf16 v[32:35], a[132:135], a[68:71], v[32:35]
    ds_read_b64_tr_b16 a[160:161], v8 offset:0
    v_fma_f32 v39, v39, s38, -v26
    v_mfma_f32_16x16x32_bf16 v[32:35], a[136:139], a[72:75], v[32:35]
    v_exp_f32 v39, v39
    v_mfma_f32_16x16x32_bf16 v[32:35], a[140:143], a[76:79], v[32:35]
    v_cvt_pk_bf16_f32 v51, v38, v39
    v_fma_f32 v40, v40, s38, -v27
    v_mfma_f32_16x16x32_bf16 v[36:39], a[144:147], a[64:67], 0
    v_exp_f32 v40, v40
    v_mfma_f32_16x16x32_bf16 v[36:39], a[148:151], a[68:71], v[36:39]
    ds_read_b64_tr_b16 a[162:163], v8 offset:8192
    v_fma_f32 v41, v41, s38, -v27
    v_mfma_f32_16x16x32_bf16 v[36:39], a[152:155], a[72:75], v[36:39]
    v_exp_f32 v41, v41
    v_mfma_f32_16x16x32_bf16 v[36:39], a[156:159], a[76:79], v[36:39]
    v_cvt_pk_bf16_f32 v52, v40, v41
    v_fma_f32 v42, v42, s38, -v27
    v_mfma_f32_16x16x32_bf16 v[128:131], a[192:195], v[48:51], v[128:131]
    v_exp_f32 v42, v42
    v_mfma_f32_16x16x32_bf16 v[132:135], a[196:199], v[48:51], v[132:135]
    ds_read_b64_tr_b16 a[164:165], v9 offset:0
    v_fma_f32 v43, v43, s38, -v27
    v_mfma_f32_16x16x32_bf16 v[136:139], a[200:203], v[48:51], v[136:139]
    v_exp_f32 v43, v43
    v_mfma_f32_16x16x32_bf16 v[140:143], a[204:207], v[48:51], v[140:143]
    v_cvt_pk_bf16_f32 v53, v42, v43
    v_fma_f32 v44, v44, s38, -v27
    v_mfma_f32_16x16x32_bf16 v[144:147], a[208:211], v[48:51], v[144:147]
    v_exp_f32 v44, v44
    v_mfma_f32_16x16x32_bf16 v[148:151], a[212:215], v[48:51], v[148:151]
    ds_read_b64_tr_b16 a[166:167], v9 offset:8192
    v_fma_f32 v45, v45, s38, -v27
    v_mfma_f32_16x16x32_bf16 v[152:155], a[216:219], v[48:51], v[152:155]
    v_exp_f32 v45, v45
    v_mfma_f32_16x16x32_bf16 v[156:159], a[220:223], v[48:51], v[156:159]
    v_cvt_pk_bf16_f32 v54, v44, v45
    v_fma_f32 v46, v46, s38, -v27
    v_mfma_f32_16x16x32_bf16 a[232:235], a[248:251], v[48:51], a[232:235]
    v_fma_f32 v47, v47, s38, -v27
    v_exp_f32 v46, v46
    v_mfma_f32_16x16x32_bf16 v[40:43], a[128:131], a[80:83], 0
    v_exp_f32 v47, v47
    v_mfma_f32_16x16x32_bf16 v[40:43], a[132:135], a[84:87], v[40:43]
    ds_read_b64_tr_b16 a[168:169], v10 offset:0
    v_cvt_pk_bf16_f32 v55, v46, v47
    v_mfma_f32_16x16x32_bf16 v[40:43], a[136:139], a[88:91], v[40:43]
    v_fma_f32 v32, v32, s38, -v28
    v_fma_f32 v33, v33, s38, -v28
    v_mfma_f32_16x16x32_bf16 v[40:43], a[140:143], a[92:95], v[40:43]
    v_exp_f32 v32, v32
    v_mfma_f32_16x16x32_bf16 v[44:47], a[144:147], a[80:83], 0
    v_exp_f32 v33, v33
    v_mfma_f32_16x16x32_bf16 v[44:47], a[148:151], a[84:87], v[44:47]
    ds_read_b64_tr_b16 a[170:171], v10 offset:8192
    v_cvt_pk_bf16_f32 v48, v32, v33
    v_mfma_f32_16x16x32_bf16 v[44:47], a[152:155], a[88:91], v[44:47]
    v_fma_f32 v34, v34, s38, -v28
    v_fma_f32 v35, v35, s38, -v28
    v_mfma_f32_16x16x32_bf16 v[44:47], a[156:159], a[92:95], v[44:47]
    v_exp_f32 v34, v34
    v_mfma_f32_16x16x32_bf16 v[160:163], a[192:195], v[52:55], v[160:163]
    v_exp_f32 v35, v35
    v_mfma_f32_16x16x32_bf16 v[164:167], a[196:199], v[52:55], v[164:167]
    ds_read_b64_tr_b16 a[172:173], v11 offset:0
    v_cvt_pk_bf16_f32 v49, v34, v35
    v_mfma_f32_16x16x32_bf16 v[168:171], a[200:203], v[52:55], v[168:171]
    v_fma_f32 v36, v36, s38, -v28
    v_fma_f32 v37, v37, s38, -v28
    v_mfma_f32_16x16x32_bf16 v[172:175], a[204:207], v[52:55], v[172:175]
    v_exp_f32 v36, v36
    v_mfma_f32_16x16x32_bf16 v[176:179], a[208:211], v[52:55], v[176:179]
    v_exp_f32 v37, v37
    v_mfma_f32_16x16x32_bf16 v[180:183], a[212:215], v[52:55], v[180:183]
    ds_read_b64_tr_b16 a[174:175], v11 offset:8192
    v_cvt_pk_bf16_f32 v50, v36, v37
    v_mfma_f32_16x16x32_bf16 v[184:187], a[216:219], v[52:55], v[184:187]
    v_fma_f32 v38, v38, s38, -v28
    v_fma_f32 v39, v39, s38, -v28
    v_mfma_f32_16x16x32_bf16 v[188:191], a[220:223], v[52:55], v[188:191]
    v_exp_f32 v38, v38
    v_mfma_f32_16x16x32_bf16 a[236:239], a[248:251], v[52:55], a[236:239]
    v_exp_f32 v39, v39
    s_waitcnt lgkmcnt(8)
    v_mfma_f32_16x16x32_bf16 v[32:35], a[96:99], a[0:3], 0
    v_cvt_pk_bf16_f32 v51, v38, v39
    v_fma_f32 v40, v40, s38, -v29
    v_mfma_f32_16x16x32_bf16 v[32:35], a[100:103], a[4:7], v[32:35]
    ds_read_b64_tr_b16 a[176:177], v12 offset:0
    v_fma_f32 v41, v41, s38, -v29
    v_mfma_f32_16x16x32_bf16 v[32:35], a[104:107], a[8:11], v[32:35]
    v_exp_f32 v40, v40
    v_mfma_f32_16x16x32_bf16 v[32:35], a[108:111], a[12:15], v[32:35]
    v_exp_f32 v41, v41
    v_mfma_f32_16x16x32_bf16 v[36:39], a[112:115], a[0:3], 0
    ds_read_b64_tr_b16 a[178:179], v12 offset:8192
    v_cvt_pk_bf16_f32 v52, v40, v41
    v_mfma_f32_16x16x32_bf16 v[36:39], a[116:119], a[4:7], v[36:39]
    v_fma_f32 v42, v42, s38, -v29
    v_fma_f32 v43, v43, s38, -v29
    v_mfma_f32_16x16x32_bf16 v[36:39], a[120:123], a[8:11], v[36:39]
    v_exp_f32 v42, v42
    v_mfma_f32_16x16x32_bf16 v[36:39], a[124:127], a[12:15], v[36:39]
    ds_read_b64_tr_b16 a[180:181], v13 offset:0
    v_exp_f32 v43, v43
    v_mfma_f32_16x16x32_bf16 v[192:195], a[192:195], v[48:51], v[192:195]
    v_cvt_pk_bf16_f32 v53, v42, v43
    v_fma_f32 v44, v44, s38, -v29
    v_mfma_f32_16x16x32_bf16 v[196:199], a[196:199], v[48:51], v[196:199]
    v_exp_f32 v44, v44
    v_mfma_f32_16x16x32_bf16 v[200:203], a[200:203], v[48:51], v[200:203]
    ds_read_b64_tr_b16 a[182:183], v13 offset:8192
    v_fma_f32 v45, v45, s38, -v29
    v_mfma_f32_16x16x32_bf16 v[204:207], a[204:207], v[48:51], v[204:207]
    v_exp_f32 v45, v45
    v_mfma_f32_16x16x32_bf16 v[208:211], a[208:211], v[48:51], v[208:211]
    v_cvt_pk_bf16_f32 v54, v44, v45
    v_fma_f32 v46, v46, s38, -v29
    v_mfma_f32_16x16x32_bf16 v[212:215], a[212:215], v[48:51], v[212:215]
    ds_read_b64_tr_b16 a[184:185], v14 offset:0
    v_fma_f32 v47, v47, s38, -v29
    v_mfma_f32_16x16x32_bf16 v[216:219], a[216:219], v[48:51], v[216:219]
    v_exp_f32 v46, v46
    v_mfma_f32_16x16x32_bf16 v[220:223], a[220:223], v[48:51], v[220:223]
    v_exp_f32 v47, v47
    v_mfma_f32_16x16x32_bf16 a[240:243], a[248:251], v[48:51], a[240:243]
    v_cvt_pk_bf16_f32 v55, v46, v47
    v_fma_f32 v32, v32, s38, -v24
    v_mfma_f32_16x16x32_bf16 v[40:43], a[96:99], a[16:19], 0
    v_exp_f32 v32, v32
    v_mfma_f32_16x16x32_bf16 v[40:43], a[100:103], a[20:23], v[40:43]
    ds_read_b64_tr_b16 a[186:187], v14 offset:8192
    v_fma_f32 v33, v33, s38, -v24
    v_mfma_f32_16x16x32_bf16 v[40:43], a[104:107], a[24:27], v[40:43]
    v_exp_f32 v33, v33
    v_mfma_f32_16x16x32_bf16 v[40:43], a[108:111], a[28:31], v[40:43]
    v_cvt_pk_bf16_f32 v48, v32, v33
    v_fma_f32 v34, v34, s38, -v24
    v_mfma_f32_16x16x32_bf16 v[44:47], a[112:115], a[16:19], 0
    ds_read_b64_tr_b16 a[188:189], v15 offset:0
    v_fma_f32 v35, v35, s38, -v24
    v_mfma_f32_16x16x32_bf16 v[44:47], a[116:119], a[20:23], v[44:47]
    v_exp_f32 v34, v34
    v_mfma_f32_16x16x32_bf16 v[44:47], a[120:123], a[24:27], v[44:47]
    v_exp_f32 v35, v35
    v_mfma_f32_16x16x32_bf16 v[44:47], a[124:127], a[28:31], v[44:47]
    ds_read_b64_tr_b16 a[190:191], v15 offset:8192
    v_cvt_pk_bf16_f32 v49, v34, v35
    v_mfma_f32_16x16x32_bf16 v[224:227], a[192:195], v[52:55], v[224:227]
    v_fma_f32 v36, v36, s38, -v24
    v_fma_f32 v37, v37, s38, -v24
    v_mfma_f32_16x16x32_bf16 v[228:231], a[196:199], v[52:55], v[228:231]
    v_exp_f32 v36, v36
    v_mfma_f32_16x16x32_bf16 v[232:235], a[200:203], v[52:55], v[232:235]
    v_exp_f32 v37, v37
    v_mfma_f32_16x16x32_bf16 v[236:239], a[204:207], v[52:55], v[236:239]
    v_cvt_pk_bf16_f32 v50, v36, v37
    v_fma_f32 v38, v38, s38, -v24
    v_mfma_f32_16x16x32_bf16 v[240:243], a[208:211], v[52:55], v[240:243]
    v_exp_f32 v38, v38
    v_mfma_f32_16x16x32_bf16 v[244:247], a[212:215], v[52:55], v[244:247]
    v_fma_f32 v39, v39, s38, -v24
    v_fma_f32 v40, v40, s38, -v25
    v_mfma_f32_16x16x32_bf16 v[248:251], a[216:219], v[52:55], v[248:251]
    v_exp_f32 v39, v39
    v_mfma_f32_16x16x32_bf16 v[252:255], a[220:223], v[52:55], v[252:255]
    v_cvt_pk_bf16_f32 v51, v38, v39
    v_fma_f32 v41, v41, s38, -v25
    v_mfma_f32_16x16x32_bf16 a[244:247], a[248:251], v[52:55], a[244:247]
    v_exp_f32 v40, v40
    v_mfma_f32_16x16x32_bf16 v[32:35], a[96:99], a[32:35], 0
    v_exp_f32 v41, v41
    v_mfma_f32_16x16x32_bf16 v[32:35], a[100:103], a[36:39], v[32:35]
    ds_read_b128 a[128:131], v4 offset:16384
    v_cvt_pk_bf16_f32 v52, v40, v41
    v_mfma_f32_16x16x32_bf16 v[32:35], a[104:107], a[40:43], v[32:35]
    s_add_u32 m0, m0, 4096
    v_fma_f32 v42, v42, s38, -v25
    v_mfma_f32_16x16x32_bf16 v[32:35], a[108:111], a[44:47], v[32:35]
    buffer_load_dwordx4 v2, s[8:11], s30 offen offset:0 nt lds
    v_mfma_f32_16x16x32_bf16 v[36:39], a[112:115], a[32:35], 0
    v_exp_f32 v42, v42
    v_mfma_f32_16x16x32_bf16 v[36:39], a[116:119], a[36:39], v[36:39]
    ds_read_b128 a[132:135], v5 offset:16384
    v_fma_f32 v43, v43, s38, -v25
    v_mfma_f32_16x16x32_bf16 v[36:39], a[120:123], a[40:43], v[36:39]
    v_exp_f32 v43, v43
    v_mfma_f32_16x16x32_bf16 v[36:39], a[124:127], a[44:47], v[36:39]
    v_cvt_pk_bf16_f32 v53, v42, v43
    s_waitcnt lgkmcnt(2)
    v_mfma_f32_16x16x32_bf16 v[64:67], a[160:163], v[48:51], v[64:67]
    v_fma_f32 v44, v44, s38, -v25
    v_fma_f32 v45, v45, s38, -v25
    v_mfma_f32_16x16x32_bf16 v[68:71], a[164:167], v[48:51], v[68:71]
    ds_read_b128 a[136:139], v6 offset:16384
    v_exp_f32 v44, v44
    v_mfma_f32_16x16x32_bf16 v[72:75], a[168:171], v[48:51], v[72:75]
    v_exp_f32 v45, v45
    v_mfma_f32_16x16x32_bf16 v[76:79], a[172:175], v[48:51], v[76:79]
    buffer_load_dwordx4 v3, s[8:11], s30 offen offset:1024 nt lds
    v_mfma_f32_16x16x32_bf16 v[80:83], a[176:179], v[48:51], v[80:83]
    v_cvt_pk_bf16_f32 v54, v44, v45
    v_fma_f32 v46, v46, s38, -v25
    v_mfma_f32_16x16x32_bf16 v[84:87], a[180:183], v[48:51], v[84:87]
    ds_read_b128 a[140:143], v7 offset:16384
    v_fma_f32 v47, v47, s38, -v25
    v_mfma_f32_16x16x32_bf16 v[88:91], a[184:187], v[48:51], v[88:91]
    v_exp_f32 v46, v46
    v_mfma_f32_16x16x32_bf16 v[92:95], a[188:191], v[48:51], v[92:95]
    v_exp_f32 v47, v47
    v_mfma_f32_16x16x32_bf16 a[224:227], a[248:251], v[48:51], a[224:227]
    v_cvt_pk_bf16_f32 v55, v46, v47
    v_fma_f32 v32, v32, s38, -v26
    v_mfma_f32_16x16x32_bf16 v[40:43], a[96:99], a[48:51], 0
    v_exp_f32 v32, v32
    v_mfma_f32_16x16x32_bf16 v[40:43], a[100:103], a[52:55], v[40:43]
    ds_read_b128 a[144:147], v4 offset:24576
    v_fma_f32 v33, v33, s38, -v26
    v_mfma_f32_16x16x32_bf16 v[40:43], a[104:107], a[56:59], v[40:43]
    v_exp_f32 v33, v33
    v_mfma_f32_16x16x32_bf16 v[40:43], a[108:111], a[60:63], v[40:43]
    buffer_load_dwordx4 v2, s[8:11], s30 offen offset:2048 nt lds
    v_mfma_f32_16x16x32_bf16 v[44:47], a[112:115], a[48:51], 0
    v_cvt_pk_bf16_f32 v48, v32, v33
    v_fma_f32 v34, v34, s38, -v26
    v_mfma_f32_16x16x32_bf16 v[44:47], a[116:119], a[52:55], v[44:47]
    ds_read_b128 a[148:151], v5 offset:24576
    v_fma_f32 v35, v35, s38, -v26
    v_mfma_f32_16x16x32_bf16 v[44:47], a[120:123], a[56:59], v[44:47]
    v_exp_f32 v34, v34
    v_mfma_f32_16x16x32_bf16 v[44:47], a[124:127], a[60:63], v[44:47]
    v_exp_f32 v35, v35
    v_mfma_f32_16x16x32_bf16 v[96:99], a[160:163], v[52:55], v[96:99]
    v_cvt_pk_bf16_f32 v49, v34, v35
    v_fma_f32 v36, v36, s38, -v26
    v_mfma_f32_16x16x32_bf16 v[100:103], a[164:167], v[52:55], v[100:103]
    ds_read_b128 a[152:155], v6 offset:24576
    v_fma_f32 v37, v37, s38, -v26
    v_mfma_f32_16x16x32_bf16 v[104:107], a[168:171], v[52:55], v[104:107]
    v_exp_f32 v36, v36
    v_mfma_f32_16x16x32_bf16 v[108:111], a[172:175], v[52:55], v[108:111]
    buffer_load_dwordx4 v3, s[8:11], s30 offen offset:3072 nt lds
    v_mfma_f32_16x16x32_bf16 v[112:115], a[176:179], v[52:55], v[112:115]
    v_exp_f32 v37, v37
    v_mfma_f32_16x16x32_bf16 v[116:119], a[180:183], v[52:55], v[116:119]
    ds_read_b128 a[156:159], v7 offset:24576
    v_cvt_pk_bf16_f32 v50, v36, v37
    v_mfma_f32_16x16x32_bf16 v[120:123], a[184:187], v[52:55], v[120:123]
    v_fma_f32 v38, v38, s38, -v26
    v_fma_f32 v39, v39, s38, -v26
    v_mfma_f32_16x16x32_bf16 v[124:127], a[188:191], v[52:55], v[124:127]
    v_exp_f32 v38, v38
    v_mfma_f32_16x16x32_bf16 a[228:231], a[248:251], v[52:55], a[228:231]
    s_cmp_eq_u32 s99, s57
    s_cselect_b32 s34, s32, 32768
    v_mfma_f32_16x16x32_bf16 v[32:35], a[96:99], a[64:67], 0
    v_exp_f32 v39, v39
    v_mfma_f32_16x16x32_bf16 v[32:35], a[100:103], a[68:71], v[32:35]
    ds_read_b64_tr_b16 a[192:193], v8 offset:16384
    v_cvt_pk_bf16_f32 v51, v38, v39
    v_mfma_f32_16x16x32_bf16 v[32:35], a[104:107], a[72:75], v[32:35]
    v_fma_f32 v40, v40, s38, -v27
    v_fma_f32 v41, v41, s38, -v27
    v_mfma_f32_16x16x32_bf16 v[32:35], a[108:111], a[76:79], v[32:35]
    v_add_u32 v4, s34, v4
    v_exp_f32 v40, v40
    v_mfma_f32_16x16x32_bf16 v[36:39], a[112:115], a[64:67], 0
    v_exp_f32 v41, v41
    v_mfma_f32_16x16x32_bf16 v[36:39], a[116:119], a[68:71], v[36:39]
    ds_read_b64_tr_b16 a[194:195], v8 offset:24576
    v_cvt_pk_bf16_f32 v52, v40, v41
    v_mfma_f32_16x16x32_bf16 v[36:39], a[120:123], a[72:75], v[36:39]
    v_fma_f32 v42, v42, s38, -v27
    v_fma_f32 v43, v43, s38, -v27
    v_mfma_f32_16x16x32_bf16 v[36:39], a[124:127], a[76:79], v[36:39]
    v_exp_f32 v42, v42
    v_mfma_f32_16x16x32_bf16 v[128:131], a[160:163], v[48:51], v[128:131]
    v_exp_f32 v43, v43
    v_mfma_f32_16x16x32_bf16 v[132:135], a[164:167], v[48:51], v[132:135]
    ds_read_b64_tr_b16 a[196:197], v9 offset:16384
    v_cvt_pk_bf16_f32 v53, v42, v43
    v_mfma_f32_16x16x32_bf16 v[136:139], a[168:171], v[48:51], v[136:139]
    v_fma_f32 v44, v44, s38, -v27
    v_fma_f32 v45, v45, s38, -v27
    v_mfma_f32_16x16x32_bf16 v[140:143], a[172:175], v[48:51], v[140:143]
    s_add_u32 s30, s30, 16384
    v_add_u32 v5, s34, v5
    v_mfma_f32_16x16x32_bf16 v[144:147], a[176:179], v[48:51], v[144:147]
    v_exp_f32 v44, v44
    v_mfma_f32_16x16x32_bf16 v[148:151], a[180:183], v[48:51], v[148:151]
    ds_read_b64_tr_b16 a[198:199], v9 offset:24576
    v_exp_f32 v45, v45
    v_mfma_f32_16x16x32_bf16 v[152:155], a[184:187], v[48:51], v[152:155]
    v_cvt_pk_bf16_f32 v54, v44, v45
    v_fma_f32 v46, v46, s38, -v27
    v_mfma_f32_16x16x32_bf16 v[156:159], a[188:191], v[48:51], v[156:159]
    v_add_u32 v6, s34, v6
    v_fma_f32 v47, v47, s38, -v27
    v_mfma_f32_16x16x32_bf16 a[232:235], a[248:251], v[48:51], a[232:235]
    v_exp_f32 v46, v46
    v_mfma_f32_16x16x32_bf16 v[40:43], a[96:99], a[80:83], 0
    v_exp_f32 v47, v47
    v_mfma_f32_16x16x32_bf16 v[40:43], a[100:103], a[84:87], v[40:43]
    ds_read_b64_tr_b16 a[200:201], v10 offset:16384
    v_cvt_pk_bf16_f32 v55, v46, v47
    v_mfma_f32_16x16x32_bf16 v[40:43], a[104:107], a[88:91], v[40:43]
    v_fma_f32 v32, v32, s38, -v28
    v_fma_f32 v33, v33, s38, -v28
    v_mfma_f32_16x16x32_bf16 v[40:43], a[108:111], a[92:95], v[40:43]
    v_exp_f32 v32, v32
    v_mfma_f32_16x16x32_bf16 v[44:47], a[112:115], a[80:83], 0
    v_exp_f32 v33, v33
    v_mfma_f32_16x16x32_bf16 v[44:47], a[116:119], a[84:87], v[44:47]
    ds_read_b64_tr_b16 a[202:203], v10 offset:24576
    v_cvt_pk_bf16_f32 v48, v32, v33
    v_mfma_f32_16x16x32_bf16 v[44:47], a[120:123], a[88:91], v[44:47]
    v_fma_f32 v34, v34, s38, -v28
    v_fma_f32 v35, v35, s38, -v28
    v_mfma_f32_16x16x32_bf16 v[44:47], a[124:127], a[92:95], v[44:47]
    v_add_u32 v7, s34, v7
    v_exp_f32 v34, v34
    v_mfma_f32_16x16x32_bf16 v[160:163], a[160:163], v[52:55], v[160:163]
    v_exp_f32 v35, v35
    v_mfma_f32_16x16x32_bf16 v[164:167], a[164:167], v[52:55], v[164:167]
    ds_read_b64_tr_b16 a[204:205], v11 offset:16384
    v_cvt_pk_bf16_f32 v49, v34, v35
    v_mfma_f32_16x16x32_bf16 v[168:171], a[168:171], v[52:55], v[168:171]
    v_fma_f32 v36, v36, s38, -v28
    v_fma_f32 v37, v37, s38, -v28
    v_mfma_f32_16x16x32_bf16 v[172:175], a[172:175], v[52:55], v[172:175]
    v_exp_f32 v36, v36
    v_mfma_f32_16x16x32_bf16 v[176:179], a[176:179], v[52:55], v[176:179]
    v_exp_f32 v37, v37
    v_mfma_f32_16x16x32_bf16 v[180:183], a[180:183], v[52:55], v[180:183]
    ds_read_b64_tr_b16 a[206:207], v11 offset:24576
    v_cvt_pk_bf16_f32 v50, v36, v37
    v_mfma_f32_16x16x32_bf16 v[184:187], a[184:187], v[52:55], v[184:187]
    v_fma_f32 v38, v38, s38, -v28
    v_fma_f32 v39, v39, s38, -v28
    v_mfma_f32_16x16x32_bf16 v[188:191], a[188:191], v[52:55], v[188:191]
    v_exp_f32 v38, v38
    v_mfma_f32_16x16x32_bf16 a[236:239], a[248:251], v[52:55], a[236:239]
    v_exp_f32 v39, v39
    s_waitcnt lgkmcnt(8)
    v_mfma_f32_16x16x32_bf16 v[32:35], a[128:131], a[0:3], 0
    v_cvt_pk_bf16_f32 v51, v38, v39
    v_fma_f32 v40, v40, s38, -v29
    v_mfma_f32_16x16x32_bf16 v[32:35], a[132:135], a[4:7], v[32:35]
    ds_read_b64_tr_b16 a[208:209], v12 offset:16384
    v_fma_f32 v41, v41, s38, -v29
    v_mfma_f32_16x16x32_bf16 v[32:35], a[136:139], a[8:11], v[32:35]
    v_exp_f32 v40, v40
    v_mfma_f32_16x16x32_bf16 v[32:35], a[140:143], a[12:15], v[32:35]
    v_exp_f32 v41, v41
    v_mfma_f32_16x16x32_bf16 v[36:39], a[144:147], a[0:3], 0
    ds_read_b64_tr_b16 a[210:211], v12 offset:24576
    v_cvt_pk_bf16_f32 v52, v40, v41
    v_mfma_f32_16x16x32_bf16 v[36:39], a[148:151], a[4:7], v[36:39]
    v_fma_f32 v42, v42, s38, -v29
    v_fma_f32 v43, v43, s38, -v29
    v_mfma_f32_16x16x32_bf16 v[36:39], a[152:155], a[8:11], v[36:39]
    v_exp_f32 v42, v42
    v_mfma_f32_16x16x32_bf16 v[36:39], a[156:159], a[12:15], v[36:39]
    ds_read_b64_tr_b16 a[212:213], v13 offset:16384
    v_exp_f32 v43, v43
    v_mfma_f32_16x16x32_bf16 v[192:195], a[160:163], v[48:51], v[192:195]
    v_cvt_pk_bf16_f32 v53, v42, v43
    v_fma_f32 v44, v44, s38, -v29
    v_mfma_f32_16x16x32_bf16 v[196:199], a[164:167], v[48:51], v[196:199]
    v_exp_f32 v44, v44
    v_mfma_f32_16x16x32_bf16 v[200:203], a[168:171], v[48:51], v[200:203]
    ds_read_b64_tr_b16 a[214:215], v13 offset:24576
    v_fma_f32 v45, v45, s38, -v29
    v_mfma_f32_16x16x32_bf16 v[204:207], a[172:175], v[48:51], v[204:207]
    v_exp_f32 v45, v45
    v_mfma_f32_16x16x32_bf16 v[208:211], a[176:179], v[48:51], v[208:211]
    v_cvt_pk_bf16_f32 v54, v44, v45
    v_fma_f32 v46, v46, s38, -v29
    v_mfma_f32_16x16x32_bf16 v[212:215], a[180:183], v[48:51], v[212:215]
    ds_read_b64_tr_b16 a[216:217], v14 offset:16384
    v_fma_f32 v47, v47, s38, -v29
    v_mfma_f32_16x16x32_bf16 v[216:219], a[184:187], v[48:51], v[216:219]
    v_exp_f32 v46, v46
    v_mfma_f32_16x16x32_bf16 v[220:223], a[188:191], v[48:51], v[220:223]
    v_exp_f32 v47, v47
    v_mfma_f32_16x16x32_bf16 a[240:243], a[248:251], v[48:51], a[240:243]
    v_cvt_pk_bf16_f32 v55, v46, v47
    v_fma_f32 v32, v32, s38, -v24
    v_mfma_f32_16x16x32_bf16 v[40:43], a[128:131], a[16:19], 0
    v_exp_f32 v32, v32
    v_mfma_f32_16x16x32_bf16 v[40:43], a[132:135], a[20:23], v[40:43]
    ds_read_b64_tr_b16 a[218:219], v14 offset:24576
    v_fma_f32 v33, v33, s38, -v24
    v_mfma_f32_16x16x32_bf16 v[40:43], a[136:139], a[24:27], v[40:43]
    v_exp_f32 v33, v33
    v_mfma_f32_16x16x32_bf16 v[40:43], a[140:143], a[28:31], v[40:43]
    v_cvt_pk_bf16_f32 v48, v32, v33
    v_fma_f32 v34, v34, s38, -v24
    v_mfma_f32_16x16x32_bf16 v[44:47], a[144:147], a[16:19], 0
    ds_read_b64_tr_b16 a[220:221], v15 offset:16384
    v_fma_f32 v35, v35, s38, -v24
    v_mfma_f32_16x16x32_bf16 v[44:47], a[148:151], a[20:23], v[44:47]
    v_exp_f32 v34, v34
    v_mfma_f32_16x16x32_bf16 v[44:47], a[152:155], a[24:27], v[44:47]
    v_exp_f32 v35, v35
    v_mfma_f32_16x16x32_bf16 v[44:47], a[156:159], a[28:31], v[44:47]
    ds_read_b64_tr_b16 a[222:223], v15 offset:24576
    v_cvt_pk_bf16_f32 v49, v34, v35
    v_mfma_f32_16x16x32_bf16 v[224:227], a[160:163], v[52:55], v[224:227]
    v_fma_f32 v36, v36, s38, -v24
    v_fma_f32 v37, v37, s38, -v24
    v_mfma_f32_16x16x32_bf16 v[228:231], a[164:167], v[52:55], v[228:231]
    v_exp_f32 v36, v36
    v_mfma_f32_16x16x32_bf16 v[232:235], a[168:171], v[52:55], v[232:235]
    s_add_u32 s35, s35, 1
    v_fma_f32 v38, v38, s38, -v24
    v_mfma_f32_16x16x32_bf16 v[236:239], a[172:175], v[52:55], v[236:239]
    v_exp_f32 v37, v37
    v_mfma_f32_16x16x32_bf16 v[240:243], a[176:179], v[52:55], v[240:243]
    s_cmp_lt_u32 s35, 5
    v_fma_f32 v39, v39, s38, -v24
    v_mfma_f32_16x16x32_bf16 v[244:247], a[180:183], v[52:55], v[244:247]
    v_exp_f32 v38, v38
    v_mfma_f32_16x16x32_bf16 v[248:251], a[184:187], v[52:55], v[248:251]
    s_waitcnt vmcnt(8) lgkmcnt(0)
    s_barrier
    v_exp_f32 v39, v39
    v_mfma_f32_16x16x32_bf16 v[252:255], a[188:191], v[52:55], v[252:255]
    v_cvt_pk_bf16_f32 v50, v36, v37
    v_cvt_pk_bf16_f32 v51, v38, v39
    v_mfma_f32_16x16x32_bf16 a[244:247], a[248:251], v[52:55], a[244:247]
    s_cbranch_scc1 L_loopB
L_loopC:
    v_mfma_f32_16x16x32_bf16 v[32:35], a[128:131], a[32:35], 0
    v_fma_f32 v40, v40, s38, -v25
    s_add_u32 s99, s99, s34
    v_mfma_f32_16x16x32_bf16 v[32:35], a[132:135], a[36:39], v[32:35]
    ds_read_b128 a[96:99], v4 offset:0
    v_add_u32 v8, s34, v8
    v_mfma_f32_16x16x32_bf16 v[32:35], a[136:139], a[40:43], v[32:35]
    v_fma_f32 v41, v41, s38, -v25
    v_exp_f32 v40, v40
    v_mfma_f32_16x16x32_bf16 v[32:35], a[140:143], a[44:47], v[32:35]
    v_exp_f32 v41, v41
    v_mfma_f32_16x16x32_bf16 v[36:39], a[144:147], a[32:35], 0
    v_cvt_pk_bf16_f32 v52, v40, v41
    v_fma_f32 v42, v42, s38, -v25
    v_mfma_f32_16x16x32_bf16 v[36:39], a[148:151], a[36:39], v[36:39]
    ds_read_b128 a[100:103], v5 offset:0
    v_add_u32 v9, s34, v9
    v_mfma_f32_16x16x32_bf16 v[36:39], a[152:155], a[40:43], v[36:39]
    v_exp_f32 v42, v42
    v_mfma_f32_16x16x32_bf16 v[36:39], a[156:159], a[44:47], v[36:39]
    ds_read_b128 a[252:255], v1 offset:0
    ds_read_b128 v[16:19], v1 offset:1024
    v_mfma_f32_16x16x32_bf16 v[64:67], a[192:195], v[48:51], v[64:67]
    v_fma_f32 v43, v43, s38, -v25
    v_fma_f32 v44, v44, s38, -v25
    v_mfma_f32_16x16x32_bf16 v[68:71], a[196:199], v[48:51], v[68:71]
    ds_read_b128 a[104:107], v6 offset:0
    v_add_u32 v10, s34, v10
    v_mfma_f32_16x16x32_bf16 v[72:75], a[200:203], v[48:51], v[72:75]
    v_exp_f32 v43, v43
    v_mfma_f32_16x16x32_bf16 v[76:79], a[204:207], v[48:51], v[76:79]
    v_cvt_pk_bf16_f32 v53, v42, v43
    v_fma_f32 v45, v45, s38, -v25
    v_mfma_f32_16x16x32_bf16 v[80:83], a[208:211], v[48:51], v[80:83]
    v_exp_f32 v44, v44
    v_mfma_f32_16x16x32_bf16 v[84:87], a[212:215], v[48:51], v[84:87]
    ds_read_b128 a[108:111], v7 offset:0
    v_add_u32 v11, s34, v11
    v_mfma_f32_16x16x32_bf16 v[88:91], a[216:219], v[48:51], v[88:91]
    v_exp_f32 v45, v45
    v_mfma_f32_16x16x32_bf16 v[92:95], a[220:223], v[48:51], v[92:95]
    s_waitcnt lgkmcnt(2)
    buffer_store_dwordx4 a[252:255], v22, s[12:15], s96 offen offset:0 sc1 nt
    v_mfma_f32_16x16x32_bf16 a[224:227], a[248:251], v[48:51], a[224:227]
    v_cvt_pk_bf16_f32 v54, v44, v45
    v_fma_f32 v46, v46, s38, -v25
    v_mfma_f32_16x16x32_bf16 v[40:43], a[128:131], a[48:51], 0
    v_exp_f32 v46, v46
    v_mfma_f32_16x16x32_bf16 v[40:43], a[132:135], a[52:55], v[40:43]
    ds_read_b128 a[112:115], v4 offset:8192
    v_add_u32 v12, s34, v12
    v_fma_f32 v47, v47, s38, -v25
    v_mfma_f32_16x16x32_bf16 v[40:43], a[136:139], a[56:59], v[40:43]
    v_exp_f32 v47, v47
    v_mfma_f32_16x16x32_bf16 v[40:43], a[140:143], a[60:63], v[40:43]
    v_cvt_pk_bf16_f32 v55, v46, v47
    v_fma_f32 v32, v32, s38, -v26
    v_mfma_f32_16x16x32_bf16 v[44:47], a[144:147], a[48:51], 0
    v_exp_f32 v32, v32
    v_mfma_f32_16x16x32_bf16 v[44:47], a[148:151], a[52:55], v[44:47]
    ds_read_b128 a[116:119], v5 offset:8192
    v_add_u32 v13, s34, v13
    v_fma_f32 v33, v33, s38, -v26
    v_mfma_f32_16x16x32_bf16 v[44:47], a[152:155], a[56:59], v[44:47]
    v_exp_f32 v33, v33
    v_mfma_f32_16x16x32_bf16 v[44:47], a[156:159], a[60:63], v[44:47]
    v_cvt_pk_bf16_f32 v48, v32, v33
    v_fma_f32 v34, v34, s38, -v26
    v_mfma_f32_16x16x32_bf16 v[96:99], a[192:195], v[52:55], v[96:99]
    v_exp_f32 v34, v34
    v_mfma_f32_16x16x32_bf16 v[100:103], a[196:199], v[52:55], v[100:103]
    ds_read_b128 a[120:123], v6 offset:8192
    v_add_u32 v14, s34, v14
    v_fma_f32 v35, v35, s38, -v26
    v_mfma_f32_16x16x32_bf16 v[104:107], a[200:203], v[52:55], v[104:107]
    v_exp_f32 v35, v35
    v_mfma_f32_16x16x32_bf16 v[108:111], a[204:207], v[52:55], v[108:111]
    v_cvt_pk_bf16_f32 v49, v34, v35
    v_fma_f32 v36, v36, s38, -v26
    v_mfma_f32_16x16x32_bf16 v[112:115], a[208:211], v[52:55], v[112:115]
    v_exp_f32 v36, v36
    v_mfma_f32_16x16x32_bf16 v[116:119], a[212:215], v[52:55], v[116:119]
    ds_read_b128 a[124:127], v7 offset:8192
    v_add_u32 v15, s34, v15
    v_fma_f32 v37, v37, s38, -v26
    v_mfma_f32_16x16x32_bf16 v[120:123], a[216:219], v[52:55], v[120:123]
    v_exp_f32 v37, v37
    v_mfma_f32_16x16x32_bf16 v[124:127], a[220:223], v[52:55], v[124:127]
    v_cvt_pk_bf16_f32 v50, v36, v37
    v_fma_f32 v38, v38, s38, -v26
    v_mfma_f32_16x16x32_bf16 a[228:231], a[248:251], v[52:55], a[228:231]
    buffer_store_dwordx4 v[16:19], v23, s[12:15], s96 offen offset:1024 sc1 nt
    v_mfma_f32_16x16x32_bf16 v[32:35], a[128:131], a[64:67], 0
    v_exp_f32 v38, v38
    v_mfma_f32_16x16x32_bf16 v[32:35], a[132:135], a[68:71], v[32:35]
    ds_read_b64_tr_b16 a[160:161], v8 offset:0
    v_fma_f32 v39, v39, s38, -v26
    v_mfma_f32_16x16x32_bf16 v[32:35], a[136:139], a[72:75], v[32:35]
    v_exp_f32 v39, v39
    v_mfma_f32_16x16x32_bf16 v[32:35], a[140:143], a[76:79], v[32:35]
    v_cvt_pk_bf16_f32 v51, v38, v39
    v_fma_f32 v40, v40, s38, -v27
    v_mfma_f32_16x16x32_bf16 v[36:39], a[144:147], a[64:67], 0
    v_exp_f32 v40, v40
    v_mfma_f32_16x16x32_bf16 v[36:39], a[148:151], a[68:71], v[36:39]
    ds_read_b64_tr_b16 a[162:163], v8 offset:8192
    v_fma_f32 v41, v41, s38, -v27
    v_mfma_f32_16x16x32_bf16 v[36:39], a[152:155], a[72:75], v[36:39]
    v_exp_f32 v41, v41
    v_mfma_f32_16x16x32_bf16 v[36:39], a[156:159], a[76:79], v[36:39]
    v_cvt_pk_bf16_f32 v52, v40, v41
    v_fma_f32 v42, v42, s38, -v27
    v_mfma_f32_16x16x32_bf16 v[128:131], a[192:195], v[48:51], v[128:131]
    v_exp_f32 v42, v42
    v_mfma_f32_16x16x32_bf16 v[132:135], a[196:199], v[48:51], v[132:135]
    ds_read_b64_tr_b16 a[164:165], v9 offset:0
    v_fma_f32 v43, v43, s38, -v27
    v_mfma_f32_16x16x32_bf16 v[136:139], a[200:203], v[48:51], v[136:139]
    v_exp_f32 v43, v43
    v_mfma_f32_16x16x32_bf16 v[140:143], a[204:207], v[48:51], v[140:143]
    v_cvt_pk_bf16_f32 v53, v42, v43
    v_fma_f32 v44, v44, s38, -v27
    v_mfma_f32_16x16x32_bf16 v[144:147], a[208:211], v[48:51], v[144:147]
    v_exp_f32 v44, v44
    v_mfma_f32_16x16x32_bf16 v[148:151], a[212:215], v[48:51], v[148:151]
    ds_read_b64_tr_b16 a[166:167], v9 offset:8192
    v_fma_f32 v45, v45, s38, -v27
    v_mfma_f32_16x16x32_bf16 v[152:155], a[216:219], v[48:51], v[152:155]
    v_exp_f32 v45, v45
    v_mfma_f32_16x16x32_bf16 v[156:159], a[220:223], v[48:51], v[156:159]
    v_cvt_pk_bf16_f32 v54, v44, v45
    v_fma_f32 v46, v46, s38, -v27
    v_mfma_f32_16x16x32_bf16 a[232:235], a[248:251], v[48:51], a[232:235]
    ds_read_b128 a[252:255], v1 offset:2048
    ds_read_b128 v[16:19], v1 offset:3072
    v_mfma_f32_16x16x32_bf16 v[40:43], a[128:131], a[80:83], 0
    v_exp_f32 v46, v46
    v_mfma_f32_16x16x32_bf16 v[40:43], a[132:135], a[84:87], v[40:43]
    ds_read_b64_tr_b16 a[168:169], v10 offset:0
    v_fma_f32 v47, v47, s38, -v27
    v_mfma_f32_16x16x32_bf16 v[40:43], a[136:139], a[88:91], v[40:43]
    v_exp_f32 v47, v47
    v_mfma_f32_16x16x32_bf16 v[40:43], a[140:143], a[92:95], v[40:43]
    v_cvt_pk_bf16_f32 v55, v46, v47
    v_fma_f32 v32, v32, s38, -v28
    v_mfma_f32_16x16x32_bf16 v[44:47], a[144:147], a[80:83], 0
    v_exp_f32 v32, v32
    v_mfma_f32_16x16x32_bf16 v[44:47], a[148:151], a[84:87], v[44:47]
    ds_read_b64_tr_b16 a[170:171], v10 offset:8192
    v_fma_f32 v33, v33, s38, -v28
    v_mfma_f32_16x16x32_bf16 v[44:47], a[152:155], a[88:91], v[44:47]
    v_exp_f32 v33, v33
    v_mfma_f32_16x16x32_bf16 v[44:47], a[156:159], a[92:95], v[44:47]
    s_waitcnt lgkmcnt(2)
    buffer_store_dwordx4 a[252:255], v22, s[12:15], s96 offen offset:2048 sc1 nt
    v_cvt_pk_bf16_f32 v48, v32, v33
    v_mfma_f32_16x16x32_bf16 v[160:163], a[192:195], v[52:55], v[160:163]
    v_fma_f32 v34, v34, s38, -v28
    v_fma_f32 v35, v35, s38, -v28
    v_mfma_f32_16x16x32_bf16 v[164:167], a[196:199], v[52:55], v[164:167]
    ds_read_b64_tr_b16 a[172:173], v11 offset:0
    v_exp_f32 v34, v34
    v_mfma_f32_16x16x32_bf16 v[168:171], a[200:203], v[52:55], v[168:171]
    v_exp_f32 v35, v35
    v_mfma_f32_16x16x32_bf16 v[172:175], a[204:207], v[52:55], v[172:175]
    v_cvt_pk_bf16_f32 v49, v34, v35
    v_fma_f32 v36, v36, s38, -v28
    v_mfma_f32_16x16x32_bf16 v[176:179], a[208:211], v[52:55], v[176:179]
    v_exp_f32 v36, v36
    v_mfma_f32_16x16x32_bf16 v[180:183], a[212:215], v[52:55], v[180:183]
    ds_read_b64_tr_b16 a[174:175], v11 offset:8192
    v_fma_f32 v37, v37, s38, -v28
    v_mfma_f32_16x16x32_bf16 v[184:187], a[216:219], v[52:55], v[184:187]
    v_exp_f32 v37, v37
    v_mfma_f32_16x16x32_bf16 v[188:191], a[220:223], v[52:55], v[188:191]
    v_cvt_pk_bf16_f32 v50, v36, v37
    v_fma_f32 v38, v38, s38, -v28
    v_mfma_f32_16x16x32_bf16 a[236:239], a[248:251], v[52:55], a[236:239]
    v_fma_f32 v39, v39, s38, -v28
    s_waitcnt lgkmcnt(10)
    v_mfma_f32_16x16x32_bf16 v[32:35], a[96:99], a[0:3], 0
    v_exp_f32 v38, v38
    v_mfma_f32_16x16x32_bf16 v[32:35], a[100:103], a[4:7], v[32:35]
    ds_read_b64_tr_b16 a[176:177], v12 offset:0
    v_exp_f32 v39, v39
    v_mfma_f32_16x16x32_bf16 v[32:35], a[104:107], a[8:11], v[32:35]
    v_cvt_pk_bf16_f32 v51, v38, v39
    v_fma_f32 v40, v40, s38, -v29
    v_mfma_f32_16x16x32_bf16 v[32:35], a[108:111], a[12:15], v[32:35]
    v_exp_f32 v40, v40
    v_mfma_f32_16x16x32_bf16 v[36:39], a[112:115], a[0:3], 0
    ds_read_b64_tr_b16 a[178:179], v12 offset:8192
    v_fma_f32 v41, v41, s38, -v29
    v_mfma_f32_16x16x32_bf16 v[36:39], a[116:119], a[4:7], v[36:39]
    v_exp_f32 v41, v41
    v_mfma_f32_16x16x32_bf16 v[36:39], a[120:123], a[8:11], v[36:39]
    v_cvt_pk_bf16_f32 v52, v40, v41
    v_fma_f32 v42, v42, s38, -v29
    v_mfma_f32_16x16x32_bf16 v[36:39], a[124:127], a[12:15], v[36:39]
    ds_read_b64_tr_b16 a[180:181], v13 offset:0
    v_fma_f32 v43, v43, s38, -v29
    v_mfma_f32_16x16x32_bf16 v[192:195], a[192:195], v[48:51], v[192:195]
    v_exp_f32 v42, v42
    v_mfma_f32_16x16x32_bf16 v[196:199], a[196:199], v[48:51], v[196:199]
    v_exp_f32 v43, v43
    v_mfma_f32_16x16x32_bf16 v[200:203], a[200:203], v[48:51], v[200:203]
    ds_read_b64_tr_b16 a[182:183], v13 offset:8192
    v_cvt_pk_bf16_f32 v53, v42, v43
    v_mfma_f32_16x16x32_bf16 v[204:207], a[204:207], v[48:51], v[204:207]
    v_fma_f32 v44, v44, s38, -v29
    v_fma_f32 v45, v45, s38, -v29
    v_mfma_f32_16x16x32_bf16 v[208:211], a[208:211], v[48:51], v[208:211]
    v_exp_f32 v44, v44
    v_mfma_f32_16x16x32_bf16 v[212:215], a[212:215], v[48:51], v[212:215]
    ds_read_b64_tr_b16 a[184:185], v14 offset:0
    v_exp_f32 v45, v45
    v_mfma_f32_16x16x32_bf16 v[216:219], a[216:219], v[48:51], v[216:219]
    v_cvt_pk_bf16_f32 v54, v44, v45
    v_fma_f32 v46, v46, s38, -v29
    v_mfma_f32_16x16x32_bf16 v[220:223], a[220:223], v[48:51], v[220:223]
    v_exp_f32 v46, v46
    v_mfma_f32_16x16x32_bf16 a[240:243], a[248:251], v[48:51], a[240:243]
    buffer_store_dwordx4 v[16:19], v23, s[12:15], s96 offen offset:3072 sc1 nt
    v_fma_f32 v47, v47, s38, -v29
    v_mfma_f32_16x16x32_bf16 v[40:43], a[96:99], a[16:19], 0
    v_exp_f32 v47, v47
    v_mfma_f32_16x16x32_bf16 v[40:43], a[100:103], a[20:23], v[40:43]
    ds_read_b64_tr_b16 a[186:187], v14 offset:8192
    v_cvt_pk_bf16_f32 v55, v46, v47
    v_mfma_f32_16x16x32_bf16 v[40:43], a[104:107], a[24:27], v[40:43]
    s_add_u32 s96, s96, 4096
    v_fma_f32 v32, v32, s38, -v24
    v_mfma_f32_16x16x32_bf16 v[40:43], a[108:111], a[28:31], v[40:43]
    v_exp_f32 v32, v32
    v_mfma_f32_16x16x32_bf16 v[44:47], a[112:115], a[16:19], 0
    ds_read_b64_tr_b16 a[188:189], v15 offset:0
    v_fma_f32 v33, v33, s38, -v24
    v_mfma_f32_16x16x32_bf16 v[44:47], a[116:119], a[20:23], v[44:47]
    v_exp_f32 v33, v33
    v_mfma_f32_16x16x32_bf16 v[44:47], a[120:123], a[24:27], v[44:47]
    v_cvt_pk_bf16_f32 v48, v32, v33
    v_fma_f32 v34, v34, s38, -v24
    v_mfma_f32_16x16x32_bf16 v[44:47], a[124:127], a[28:31], v[44:47]
    ds_read_b64_tr_b16 a[190:191], v15 offset:8192
    v_fma_f32 v35, v35, s38, -v24
    v_mfma_f32_16x16x32_bf16 v[224:227], a[192:195], v[52:55], v[224:227]
    v_exp_f32 v34, v34
    v_mfma_f32_16x16x32_bf16 v[228:231], a[196:199], v[52:55], v[228:231]
    v_exp_f32 v35, v35
    v_mfma_f32_16x16x32_bf16 v[232:235], a[200:203], v[52:55], v[232:235]
    v_cvt_pk_bf16_f32 v49, v34, v35
    v_fma_f32 v36, v36, s38, -v24
    v_mfma_f32_16x16x32_bf16 v[236:239], a[204:207], v[52:55], v[236:239]
    v_exp_f32 v36, v36
    v_mfma_f32_16x16x32_bf16 v[240:243], a[208:211], v[52:55], v[240:243]
    v_fma_f32 v37, v37, s38, -v24
    v_fma_f32 v38, v38, s38, -v24
    v_mfma_f32_16x16x32_bf16 v[244:247], a[212:215], v[52:55], v[244:247]
    s_cmp_eq_u32 s35, 6
    v_fma_f32 v39, v39, s38, -v24
    v_exp_f32 v37, v37
    v_mfma_f32_16x16x32_bf16 v[248:251], a[216:219], v[52:55], v[248:251]
    v_exp_f32 v38, v38
    v_exp_f32 v39, v39
    v_mfma_f32_16x16x32_bf16 v[252:255], a[220:223], v[52:55], v[252:255]
    v_cvt_pk_bf16_f32 v50, v36, v37
    v_cvt_pk_bf16_f32 v51, v38, v39
    v_mfma_f32_16x16x32_bf16 a[244:247], a[248:251], v[52:55], a[244:247]
    s_cbranch_scc1 L_last
    v_mfma_f32_16x16x32_bf16 v[32:35], a[96:99], a[32:35], 0
    v_fma_f32 v40, v40, s38, -v25
    v_fma_f32 v41, v41, s38, -v25
    v_mfma_f32_16x16x32_bf16 v[32:35], a[100:103], a[36:39], v[32:35]
    ds_read_b128 a[128:131], v4 offset:16384
    v_exp_f32 v40, v40
    v_mfma_f32_16x16x32_bf16 v[32:35], a[104:107], a[40:43], v[32:35]
    v_exp_f32 v41, v41
    v_mfma_f32_16x16x32_bf16 v[32:35], a[108:111], a[44:47], v[32:35]
    v_cvt_pk_bf16_f32 v52, v40, v41
    v_fma_f32 v42, v42, s38, -v25
    v_mfma_f32_16x16x32_bf16 v[36:39], a[112:115], a[32:35], 0
    v_exp_f32 v42, v42
    v_mfma_f32_16x16x32_bf16 v[36:39], a[116:119], a[36:39], v[36:39]
    ds_read_b128 a[132:135], v5 offset:16384
    v_fma_f32 v43, v43, s38, -v25
    v_mfma_f32_16x16x32_bf16 v[36:39], a[120:123], a[40:43], v[36:39]
    v_exp_f32 v43, v43
    v_mfma_f32_16x16x32_bf16 v[36:39], a[124:127], a[44:47], v[36:39]
    ds_read_b128 a[252:255], v1 offset:4096
    ds_read_b128 v[16:19], v1 offset:5120
    v_cvt_pk_bf16_f32 v53, v42, v43
    s_waitcnt lgkmcnt(4)
    v_mfma_f32_16x16x32_bf16 v[64:67], a[160:163], v[48:51], v[64:67]
    v_fma_f32 v44, v44, s38, -v25
    v_fma_f32 v45, v45, s38, -v25
    v_mfma_f32_16x16x32_bf16 v[68:71], a[164:167], v[48:51], v[68:71]
    ds_read_b128 a[136:139], v6 offset:16384
    v_exp_f32 v44, v44
    v_mfma_f32_16x16x32_bf16 v[72:75], a[168:171], v[48:51], v[72:75]
    v_exp_f32 v45, v45
    v_mfma_f32_16x16x32_bf16 v[76:79], a[172:175], v[48:51], v[76:79]
    v_cvt_pk_bf16_f32 v54, v44, v45
    v_fma_f32 v46, v46, s38, -v25
    v_mfma_f32_16x16x32_bf16 v[80:83], a[176:179], v[48:51], v[80:83]
    v_exp_f32 v46, v46
    v_mfma_f32_16x16x32_bf16 v[84:87], a[180:183], v[48:51], v[84:87]
    ds_read_b128 a[140:143], v7 offset:16384
    v_fma_f32 v47, v47, s38, -v25
    v_mfma_f32_16x16x32_bf16 v[88:91], a[184:187], v[48:51], v[88:91]
    v_exp_f32 v47, v47
    v_mfma_f32_16x16x32_bf16 v[92:95], a[188:191], v[48:51], v[92:95]
    s_waitcnt lgkmcnt(2)
    buffer_store_dwordx4 a[252:255], v22, s[12:15], s96 offen offset:0 sc1 nt
    v_mfma_f32_16x16x32_bf16 a[224:227], a[248:251], v[48:51], a[224:227]
    v_cvt_pk_bf16_f32 v55, v46, v47
    v_fma_f32 v32, v32, s38, -v26
    v_mfma_f32_16x16x32_bf16 v[40:43], a[96:99], a[48:51], 0
    v_exp_f32 v32, v32
    v_mfma_f32_16x16x32_bf16 v[40:43], a[100:103], a[52:55], v[40:43]
    ds_read_b128 a[144:147], v4 offset:24576
    v_fma_f32 v33, v33, s38, -v26
    v_mfma_f32_16x16x32_bf16 v[40:43], a[104:107], a[56:59], v[40:43]
    v_exp_f32 v33, v33
    v_mfma_f32_16x16x32_bf16 v[40:43], a[108:111], a[60:63], v[40:43]
    v_cvt_pk_bf16_f32 v48, v32, v33
    v_fma_f32 v34, v34, s38, -v26
    v_mfma_f32_16x16x32_bf16 v[44:47], a[112:115], a[48:51], 0
    v_exp_f32 v34, v34
    v_mfma_f32_16x16x32_bf16 v[44:47], a[116:119], a[52:55], v[44:47]
    ds_read_b128 a[148:151], v5 offset:24576
    v_fma_f32 v35, v35, s38, -v26
    v_mfma_f32_16x16x32_bf16 v[44:47], a[120:123], a[56:59], v[44:47]
    v_exp_f32 v35, v35
    v_mfma_f32_16x16x32_bf16 v[44:47], a[124:127], a[60:63], v[44:47]
    v_cvt_pk_bf16_f32 v49, v34, v35
    v_fma_f32 v36, v36, s38, -v26
    v_mfma_f32_16x16x32_bf16 v[96:99], a[160:163], v[52:55], v[96:99]
    v_exp_f32 v36, v36
    v_mfma_f32_16x16x32_bf16 v[100:103], a[164:167], v[52:55], v[100:103]
    ds_read_b128 a[152:155], v6 offset:24576
    v_fma_f32 v37, v37, s38, -v26
    v_mfma_f32_16x16x32_bf16 v[104:107], a[168:171], v[52:55], v[104:107]
    v_exp_f32 v37, v37
    v_mfma_f32_16x16x32_bf16 v[108:111], a[172:175], v[52:55], v[108:111]
    v_cvt_pk_bf16_f32 v50, v36, v37
    v_fma_f32 v38, v38, s38, -v26
    v_mfma_f32_16x16x32_bf16 v[112:115], a[176:179], v[52:55], v[112:115]
    v_exp_f32 v38, v38
    v_mfma_f32_16x16x32_bf16 v[116:119], a[180:183], v[52:55], v[116:119]
    ds_read_b128 a[156:159], v7 offset:24576
    v_fma_f32 v39, v39, s38, -v26
    v_mfma_f32_16x16x32_bf16 v[120:123], a[184:187], v[52:55], v[120:123]
    v_exp_f32 v39, v39
    v_mfma_f32_16x16x32_bf16 v[124:127], a[188:191], v[52:55], v[124:127]
    v_cvt_pk_bf16_f32 v51, v38, v39
    v_fma_f32 v40, v40, s38, -v27
    v_mfma_f32_16x16x32_bf16 a[228:231], a[248:251], v[52:55], a[228:231]
    buffer_store_dwordx4 v[16:19], v23, s[12:15], s96 offen offset:1024 sc1 nt
    s_cmp_eq_u32 s99, s57
    s_cselect_b32 s34, s32, 32768
    v_mfma_f32_16x16x32_bf16 v[32:35], a[96:99], a[64:67], 0
    v_exp_f32 v40, v40
    v_mfma_f32_16x16x32_bf16 v[32:35], a[100:103], a[68:71], v[32:35]
    ds_read_b64_tr_b16 a[192:193], v8 offset:16384
    v_fma_f32 v41, v41, s38, -v27
    v_mfma_f32_16x16x32_bf16 v[32:35], a[104:107], a[72:75], v[32:35]
    v_exp_f32 v41, v41
    v_mfma_f32_16x16x32_bf16 v[32:35], a[108:111], a[76:79], v[32:35]
    v_add_u32 v4, s34, v4
    v_cvt_pk_bf16_f32 v52, v40, v41
    v_mfma_f32_16x16x32_bf16 v[36:39], a[112:115], a[64:67], 0
    v_fma_f32 v42, v42, s38, -v27
    v_fma_f32 v43, v43, s38, -v27
    v_mfma_f32_16x16x32_bf16 v[36:39], a[116:119], a[68:71], v[36:39]
    ds_read_b64_tr_b16 a[194:195], v8 offset:24576
    v_exp_f32 v42, v42
    v_mfma_f32_16x16x32_bf16 v[36:39], a[120:123], a[72:75], v[36:39]
    v_exp_f32 v43, v43
    v_mfma_f32_16x16x32_bf16 v[36:39], a[124:127], a[76:79], v[36:39]
    v_cvt_pk_bf16_f32 v53, v42, v43
    v_fma_f32 v44, v44, s38, -v27
    v_mfma_f32_16x16x32_bf16 v[128:131], a[160:163], v[48:51], v[128:131]
    v_exp_f32 v44, v44
    v_mfma_f32_16x16x32_bf16 v[132:135], a[164:167], v[48:51], v[132:135]
    ds_read_b64_tr_b16 a[196:197], v9 offset:16384
    v_fma_f32 v45, v45, s38, -v27
    v_mfma_f32_16x16x32_bf16 v[136:139], a[168:171], v[48:51], v[136:139]
    v_exp_f32 v45, v45
    v_mfma_f32_16x16x32_bf16 v[140:143], a[172:175], v[48:51], v[140:143]
    v_add_u32 v5, s34, v5
    v_cvt_pk_bf16_f32 v54, v44, v45
    v_mfma_f32_16x16x32_bf16 v[144:147], a[176:179], v[48:51], v[144:147]
    v_fma_f32 v46, v46, s38, -v27
    v_fma_f32 v47, v47, s38, -v27
    v_mfma_f32_16x16x32_bf16 v[148:151], a[180:183], v[48:51], v[148:151]
    ds_read_b64_tr_b16 a[198:199], v9 offset:24576
    v_exp_f32 v46, v46
    v_mfma_f32_16x16x32_bf16 v[152:155], a[184:187], v[48:51], v[152:155]
    v_exp_f32 v47, v47
    v_mfma_f32_16x16x32_bf16 v[156:159], a[188:191], v[48:51], v[156:159]
    v_add_u32 v6, s34, v6
    v_cvt_pk_bf16_f32 v55, v46, v47
    v_mfma_f32_16x16x32_bf16 a[232:235], a[248:251], v[48:51], a[232:235]
    ds_read_b128 a[252:255], v1 offset:6144
    ds_read_b128 v[16:19], v1 offset:7168
    v_mfma_f32_16x16x32_bf16 v[40:43], a[96:99], a[80:83], 0
    v_fma_f32 v32, v32, s38, -v28
    v_fma_f32 v33, v33, s38, -v28
    v_mfma_f32_16x16x32_bf16 v[40:43], a[100:103], a[84:87], v[40:43]
    ds_read_b64_tr_b16 a[200:201], v10 offset:16384
    v_exp_f32 v32, v32
    v_mfma_f32_16x16x32_bf16 v[40:43], a[104:107], a[88:91], v[40:43]
    v_exp_f32 v33, v33
    v_mfma_f32_16x16x32_bf16 v[40:43], a[108:111], a[92:95], v[40:43]
    v_cvt_pk_bf16_f32 v48, v32, v33
    v_fma_f32 v34, v34, s38, -v28
    v_mfma_f32_16x16x32_bf16 v[44:47], a[112:115], a[80:83], 0
    v_exp_f32 v34, v34
    v_mfma_f32_16x16x32_bf16 v[44:47], a[116:119], a[84:87], v[44:47]
    ds_read_b64_tr_b16 a[202:203], v10 offset:24576
    v_fma_f32 v35, v35, s38, -v28
    v_mfma_f32_16x16x32_bf16 v[44:47], a[120:123], a[88:91], v[44:47]
    v_exp_f32 v35, v35
    v_mfma_f32_16x16x32_bf16 v[44:47], a[124:127], a[92:95], v[44:47]
    s_waitcnt lgkmcnt(2)
    buffer_store_dwordx4 a[252:255], v22, s[12:15], s96 offen offset:2048 sc1 nt
    v_add_u32 v7, s34, v7
    v_mfma_f32_16x16x32_bf16 v[160:163], a[160:163], v[52:55], v[160:163]
    v_cvt_pk_bf16_f32 v49, v34, v35
    v_fma_f32 v36, v36, s38, -v28
    v_mfma_f32_16x16x32_bf16 v[164:167], a[164:167], v[52:55], v[164:167]
    ds_read_b64_tr_b16 a[204:205], v11 offset:16384
    v_fma_f32 v37, v37, s38, -v28
    v_mfma_f32_16x16x32_bf16 v[168:171], a[168:171], v[52:55], v[168:171]
    v_exp_f32 v36, v36
    v_mfma_f32_16x16x32_bf16 v[172:175], a[172:175], v[52:55], v[172:175]
    v_exp_f32 v37, v37
    v_mfma_f32_16x16x32_bf16 v[176:179], a[176:179], v[52:55], v[176:179]
    v_cvt_pk_bf16_f32 v50, v36, v37
    v_fma_f32 v38, v38, s38, -v28
    v_mfma_f32_16x16x32_bf16 v[180:183], a[180:183], v[52:55], v[180:183]
    ds_read_b64_tr_b16 a[206:207], v11 offset:24576
    v_fma_f32 v39, v39, s38, -v28
    v_mfma_f32_16x16x32_bf16 v[184:187], a[184:187], v[52:55], v[184:187]
    v_exp_f32 v38, v38
    v_mfma_f32_16x16x32_bf16 v[188:191], a[188:191], v[52:55], v[188:191]
    v_exp_f32 v39, v39
    v_mfma_f32_16x16x32_bf16 a[236:239], a[248:251], v[52:55], a[236:239]
    v_cvt_pk_bf16_f32 v51, v38, v39
    s_waitcnt lgkmcnt(10)
    v_mfma_f32_16x16x32_bf16 v[32:35], a[128:131], a[0:3], 0
    v_fma_f32 v40, v40, s38, -v29
    v_fma_f32 v41, v41, s38, -v29
    v_mfma_f32_16x16x32_bf16 v[32:35], a[132:135], a[4:7], v[32:35]
    ds_read_b64_tr_b16 a[208:209], v12 offset:16384
    v_exp_f32 v40, v40
    v_mfma_f32_16x16x32_bf16 v[32:35], a[136:139], a[8:11], v[32:35]
    v_exp_f32 v41, v41
    v_mfma_f32_16x16x32_bf16 v[32:35], a[140:143], a[12:15], v[32:35]
    v_cvt_pk_bf16_f32 v52, v40, v41
    v_fma_f32 v42, v42, s38, -v29
    v_mfma_f32_16x16x32_bf16 v[36:39], a[144:147], a[0:3], 0
    ds_read_b64_tr_b16 a[210:211], v12 offset:24576
    v_fma_f32 v43, v43, s38, -v29
    v_mfma_f32_16x16x32_bf16 v[36:39], a[148:151], a[4:7], v[36:39]
    v_exp_f32 v42, v42
    v_mfma_f32_16x16x32_bf16 v[36:39], a[152:155], a[8:11], v[36:39]
    v_exp_f32 v43, v43
    v_mfma_f32_16x16x32_bf16 v[36:39], a[156:159], a[12:15], v[36:39]
    ds_read_b64_tr_b16 a[212:213], v13 offset:16384
    v_cvt_pk_bf16_f32 v53, v42, v43
    v_mfma_f32_16x16x32_bf16 v[192:195], a[160:163], v[48:51], v[192:195]
    v_fma_f32 v44, v44, s38, -v29
    v_fma_f32 v45, v45, s38, -v29
    v_mfma_f32_16x16x32_bf16 v[196:199], a[164:167], v[48:51], v[196:199]
    v_exp_f32 v44, v44
    v_mfma_f32_16x16x32_bf16 v[200:203], a[168:171], v[48:51], v[200:203]
    ds_read_b64_tr_b16 a[214:215], v13 offset:24576
    v_exp_f32 v45, v45
    v_mfma_f32_16x16x32_bf16 v[204:207], a[172:175], v[48:51], v[204:207]
    v_cvt_pk_bf16_f32 v54, v44, v45
    v_fma_f32 v46, v46, s38, -v29
    v_mfma_f32_16x16x32_bf16 v[208:211], a[176:179], v[48:51], v[208:211]
    v_exp_f32 v46, v46
    v_mfma_f32_16x16x32_bf16 v[212:215], a[180:183], v[48:51], v[212:215]
    ds_read_b64_tr_b16 a[216:217], v14 offset:16384
    v_fma_f32 v47, v47, s38, -v29
    v_mfma_f32_16x16x32_bf16 v[216:219], a[184:187], v[48:51], v[216:219]
    v_exp_f32 v47, v47
    v_mfma_f32_16x16x32_bf16 v[220:223], a[188:191], v[48:51], v[220:223]
    v_cvt_pk_bf16_f32 v55, v46, v47
    v_fma_f32 v32, v32, s38, -v24
    v_mfma_f32_16x16x32_bf16 a[240:243], a[248:251], v[48:51], a[240:243]
    buffer_store_dwordx4 v[16:19], v23, s[12:15], s96 offen offset:3072 sc1 nt
    v_mfma_f32_16x16x32_bf16 v[40:43], a[128:131], a[16:19], 0
    v_exp_f32 v32, v32
    v_mfma_f32_16x16x32_bf16 v[40:43], a[132:135], a[20:23], v[40:43]
    ds_read_b64_tr_b16 a[218:219], v14 offset:24576
    v_fma_f32 v33, v33, s38, -v24
    v_mfma_f32_16x16x32_bf16 v[40:43], a[136:139], a[24:27], v[40:43]
    s_add_u32 s96, s96, 4096
    v_exp_f32 v33, v33
    v_mfma_f32_16x16x32_bf16 v[40:43], a[140:143], a[28:31], v[40:43]
    v_xor_b32 v1, 8192, v1
    v_cvt_pk_bf16_f32 v48, v32, v33
    v_mfma_f32_16x16x32_bf16 v[44:47], a[144:147], a[16:19], 0
    ds_read_b64_tr_b16 a[220:221], v15 offset:16384
    v_fma_f32 v34, v34, s38, -v24
    v_mfma_f32_16x16x32_bf16 v[44:47], a[148:151], a[20:23], v[44:47]
    v_fma_f32 v35, v35, s38, -v24
    v_exp_f32 v34, v34
    v_mfma_f32_16x16x32_bf16 v[44:47], a[152:155], a[24:27], v[44:47]
    v_exp_f32 v35, v35
    v_mfma_f32_16x16x32_bf16 v[44:47], a[156:159], a[28:31], v[44:47]
    ds_read_b64_tr_b16 a[222:223], v15 offset:24576
    v_cvt_pk_bf16_f32 v49, v34, v35
    v_mfma_f32_16x16x32_bf16 v[224:227], a[160:163], v[52:55], v[224:227]
    v_fma_f32 v36, v36, s38, -v24
    v_fma_f32 v37, v37, s38, -v24
    v_mfma_f32_16x16x32_bf16 v[228:231], a[164:167], v[52:55], v[228:231]
    v_exp_f32 v36, v36
    v_mfma_f32_16x16x32_bf16 v[232:235], a[168:171], v[52:55], v[232:235]
    s_add_u32 s35, s35, 1
    v_fma_f32 v38, v38, s38, -v24
    v_mfma_f32_16x16x32_bf16 v[236:239], a[172:175], v[52:55], v[236:239]
    v_exp_f32 v37, v37
    v_mfma_f32_16x16x32_bf16 v[240:243], a[176:179], v[52:55], v[240:243]
    v_fma_f32 v39, v39, s38, -v24
    v_exp_f32 v38, v38
    v_mfma_f32_16x16x32_bf16 v[244:247], a[180:183], v[52:55], v[244:247]
    v_exp_f32 v39, v39
    v_mfma_f32_16x16x32_bf16 v[248:251], a[184:187], v[52:55], v[248:251]
    s_waitcnt vmcnt(8) lgkmcnt(0)
    s_barrier
    v_mfma_f32_16x16x32_bf16 v[252:255], a[188:191], v[52:55], v[252:255]
    v_cvt_pk_bf16_f32 v50, v36, v37
    v_cvt_pk_bf16_f32 v51, v38, v39
    v_mfma_f32_16x16x32_bf16 a[244:247], a[248:251], v[52:55], a[244:247]
    s_branch L_loopC
L_last:
    v_mfma_f32_16x16x32_bf16 v[32:35], a[96:99], a[32:35], 0
    ds_read_b128 a[128:131], v4 offset:16384
    ds_read_b128 a[132:135], v5 offset:16384
    v_mfma_f32_16x16x32_bf16 v[32:35], a[100:103], a[36:39], v[32:35]
    ds_read_b128 a[136:139], v6 offset:16384
    ds_read_b128 a[140:143], v7 offset:16384
    v_mfma_f32_16x16x32_bf16 v[32:35], a[104:107], a[40:43], v[32:35]
    ds_read_b128 a[144:147], v4 offset:24576
    ds_read_b128 a[148:151], v5 offset:24576
    v_mfma_f32_16x16x32_bf16 v[32:35], a[108:111], a[44:47], v[32:35]
    ds_read_b128 a[152:155], v6 offset:24576
    ds_read_b128 a[156:159], v7 offset:24576
    v_mfma_f32_16x16x32_bf16 v[36:39], a[112:115], a[32:35], 0
    s_mov_b64 s[46:47], 0
    v_fma_f32 v40, v40, s38, -v25
    v_mfma_f32_16x16x32_bf16 v[36:39], a[116:119], a[36:39], v[36:39]
    ds_read_b128 a[252:255], v1 offset:4096
    v_fma_f32 v41, v41, s38, -v25
    v_mfma_f32_16x16x32_bf16 v[36:39], a[120:123], a[40:43], v[36:39]
    v_exp_f32 v40, v40
    v_exp_f32 v41, v41
    v_mfma_f32_16x16x32_bf16 v[36:39], a[124:127], a[44:47], v[36:39]
    v_cvt_pk_bf16_f32 v52, v40, v41
    s_waitcnt lgkmcnt(8)
    v_mfma_f32_16x16x32_bf16 v[64:67], a[160:163], v[48:51], v[64:67]
    v_fma_f32 v42, v42, s38, -v25
    v_fma_f32 v43, v43, s38, -v25
    v_mfma_f32_16x16x32_bf16 v[68:71], a[164:167], v[48:51], v[68:71]
    ds_read_b64_tr_b16 a[192:193], v8 offset:16384
    v_exp_f32 v42, v42
    v_mfma_f32_16x16x32_bf16 v[72:75], a[168:171], v[48:51], v[72:75]
    v_exp_f32 v43, v43
    v_mfma_f32_16x16x32_bf16 v[76:79], a[172:175], v[48:51], v[76:79]
    ds_read_b64_tr_b16 a[194:195], v8 offset:24576
    v_cvt_pk_bf16_f32 v53, v42, v43
    v_mfma_f32_16x16x32_bf16 v[80:83], a[176:179], v[48:51], v[80:83]
    s_waitcnt lgkmcnt(2)
    buffer_store_dwordx4 a[252:255], v22, s[12:15], s96 offen offset:0 sc1 nt
    v_mfma_f32_16x16x32_bf16 v[84:87], a[180:183], v[48:51], v[84:87]
    ds_read_b64_tr_b16 a[196:197], v9 offset:16384
    v_fma_f32 v44, v44, s38, -v25
    v_fma_f32 v45, v45, s38, -v25
    v_mfma_f32_16x16x32_bf16 v[88:91], a[184:187], v[48:51], v[88:91]
    v_exp_f32 v44, v44
    v_exp_f32 v45, v45
    v_mfma_f32_16x16x32_bf16 v[92:95], a[188:191], v[48:51], v[92:95]
    ds_read_b64_tr_b16 a[198:199], v9 offset:24576
    v_cvt_pk_bf16_f32 v54, v44, v45
    v_mfma_f32_16x16x32_bf16 a[224:227], a[248:251], v[48:51], a[224:227]
    v_fma_f32 v46, v46, s38, -v25
    s_waitcnt lgkmcnt(5)
    v_mfma_f32_16x16x32_bf16 v[40:43], a[128:131], a[0:3], 0
    v_exp_f32 v46, v46
    v_mfma_f32_16x16x32_bf16 v[40:43], a[132:135], a[4:7], v[40:43]
    ds_read_b64_tr_b16 a[200:201], v10 offset:16384
    ds_read_b128 v[16:19], v1 offset:5120
    v_fma_f32 v47, v47, s38, -v25
    v_mfma_f32_16x16x32_bf16 v[40:43], a[136:139], a[8:11], v[40:43]
    v_exp_f32 v47, v47
    v_mfma_f32_16x16x32_bf16 v[40:43], a[140:143], a[12:15], v[40:43]
    ds_read_b64_tr_b16 a[202:203], v10 offset:24576
    v_cvt_pk_bf16_f32 v55, v46, v47
    v_mfma_f32_16x16x32_bf16 v[44:47], a[144:147], a[0:3], 0
    v_fma_f32 v32, v32, s38, -v26
    v_fma_f32 v33, v33, s38, -v26
    v_mfma_f32_16x16x32_bf16 v[44:47], a[148:151], a[4:7], v[44:47]
    ds_read_b64_tr_b16 a[204:205], v11 offset:16384
    v_exp_f32 v32, v32
    v_mfma_f32_16x16x32_bf16 v[44:47], a[152:155], a[8:11], v[44:47]
    v_exp_f32 v33, v33
    v_mfma_f32_16x16x32_bf16 v[44:47], a[156:159], a[12:15], v[44:47]
    ds_read_b64_tr_b16 a[206:207], v11 offset:24576
    v_cvt_pk_bf16_f32 v48, v32, v33
    v_mfma_f32_16x16x32_bf16 v[96:99], a[160:163], v[52:55], v[96:99]
    s_waitcnt lgkmcnt(3)
    buffer_store_dwordx4 v[16:19], v23, s[12:15], s96 offen offset:1024 sc1 nt
    v_mfma_f32_16x16x32_bf16 v[100:103], a[164:167], v[52:55], v[100:103]
    ds_read_b64_tr_b16 a[208:209], v12 offset:16384
    v_fma_f32 v34, v34, s38, -v26
    v_mfma_f32_16x16x32_bf16 v[104:107], a[168:171], v[52:55], v[104:107]
    v_exp_f32 v34, v34
    v_mfma_f32_16x16x32_bf16 v[108:111], a[172:175], v[52:55], v[108:111]
    ds_read_b64_tr_b16 a[210:211], v12 offset:24576
    v_fma_f32 v35, v35, s38, -v26
    v_mfma_f32_16x16x32_bf16 v[112:115], a[176:179], v[52:55], v[112:115]
    v_exp_f32 v35, v35
    v_mfma_f32_16x16x32_bf16 v[116:119], a[180:183], v[52:55], v[116:119]
    ds_read_b64_tr_b16 a[212:213], v13 offset:16384
    v_cvt_pk_bf16_f32 v49, v34, v35
    v_mfma_f32_16x16x32_bf16 v[120:123], a[184:187], v[52:55], v[120:123]
    ds_read_b128 a[252:255], v1 offset:6144
    v_fma_f32 v36, v36, s38, -v26
    v_mfma_f32_16x16x32_bf16 v[124:127], a[188:191], v[52:55], v[124:127]
    ds_read_b64_tr_b16 a[214:215], v13 offset:24576
    v_fma_f32 v37, v37, s38, -v26
    v_mfma_f32_16x16x32_bf16 a[228:231], a[248:251], v[52:55], a[228:231]
    v_exp_f32 v36, v36
    v_exp_f32 v37, v37
    v_mfma_f32_16x16x32_bf16 v[32:35], a[128:131], a[16:19], 0
    v_cvt_pk_bf16_f32 v50, v36, v37
    v_fma_f32 v38, v38, s38, -v26
    v_mfma_f32_16x16x32_bf16 v[32:35], a[132:135], a[20:23], v[32:35]
    ds_read_b64_tr_b16 a[216:217], v14 offset:16384
    v_fma_f32 v39, v39, s38, -v26
    v_mfma_f32_16x16x32_bf16 v[32:35], a[136:139], a[24:27], v[32:35]
    v_exp_f32 v38, v38
    v_exp_f32 v39, v39
    v_mfma_f32_16x16x32_bf16 v[32:35], a[140:143], a[28:31], v[32:35]
    ds_read_b64_tr_b16 a[218:219], v14 offset:24576
    v_cvt_pk_bf16_f32 v51, v38, v39
    v_mfma_f32_16x16x32_bf16 v[36:39], a[144:147], a[16:19], 0
    s_waitcnt lgkmcnt(3)
    buffer_store_dwordx4 a[252:255], v22, s[12:15], s96 offen offset:2048 sc1 nt
    v_mfma_f32_16x16x32_bf16 v[36:39], a[148:151], a[20:23], v[36:39]
    ds_read_b64_tr_b16 a[220:221], v15 offset:16384
    v_fma_f32 v40, v40, s38, -v24
    v_mfma_f32_16x16x32_bf16 v[36:39], a[152:155], a[24:27], v[36:39]
    v_exp_f32 v40, v40
    v_mfma_f32_16x16x32_bf16 v[36:39], a[156:159], a[28:31], v[36:39]
    ds_read_b64_tr_b16 a[222:223], v15 offset:24576
    v_fma_f32 v41, v41, s38, -v24
    v_mfma_f32_16x16x32_bf16 v[128:131], a[160:163], v[48:51], v[128:131]
    v_exp_f32 v41, v41
    v_mfma_f32_16x16x32_bf16 v[132:135], a[164:167], v[48:51], v[132:135]
    ds_read_b128 v[16:19], v1 offset:7168
    v_cvt_pk_bf16_f32 v52, v40, v41
    v_mfma_f32_16x16x32_bf16 v[136:139], a[168:171], v[48:51], v[136:139]
    v_fma_f32 v42, v42, s38, -v24
    v_fma_f32 v43, v43, s38, -v24
    v_mfma_f32_16x16x32_bf16 v[140:143], a[172:175], v[48:51], v[140:143]
    v_exp_f32 v42, v42
    v_mfma_f32_16x16x32_bf16 v[144:147], a[176:179], v[48:51], v[144:147]
    v_exp_f32 v43, v43
    v_mfma_f32_16x16x32_bf16 v[148:151], a[180:183], v[48:51], v[148:151]
    v_cvt_pk_bf16_f32 v53, v42, v43
    v_fma_f32 v44, v44, s38, -v24
    v_mfma_f32_16x16x32_bf16 v[152:155], a[184:187], v[48:51], v[152:155]
    v_fma_f32 v45, v45, s38, -v24
    v_exp_f32 v44, v44
    v_mfma_f32_16x16x32_bf16 v[156:159], a[188:191], v[48:51], v[156:159]
    v_exp_f32 v45, v45
    v_mfma_f32_16x16x32_bf16 a[232:235], a[248:251], v[48:51], a[232:235]
    s_waitcnt lgkmcnt(0)
    buffer_store_dwordx4 v[16:19], v23, s[12:15], s96 offen offset:3072 sc1 nt
    v_cvt_pk_bf16_f32 v54, v44, v45
    v_mfma_f32_16x16x32_bf16 v[40:43], a[128:131], a[32:35], 0
    v_fma_f32 v46, v46, s38, -v24
    v_fma_f32 v47, v47, s38, -v24
    v_mfma_f32_16x16x32_bf16 v[40:43], a[132:135], a[36:39], v[40:43]
    v_exp_f32 v46, v46
    v_exp_f32 v47, v47
    v_mfma_f32_16x16x32_bf16 v[40:43], a[136:139], a[40:43], v[40:43]
    v_cvt_pk_bf16_f32 v55, v46, v47
    v_fma_f32 v32, v32, s38, -v25
    v_mfma_f32_16x16x32_bf16 v[40:43], a[140:143], a[44:47], v[40:43]
    v_fma_f32 v33, v33, s38, -v25
    v_exp_f32 v32, v32
    v_mfma_f32_16x16x32_bf16 v[44:47], a[144:147], a[32:35], 0
    v_exp_f32 v33, v33
    v_mfma_f32_16x16x32_bf16 v[44:47], a[148:151], a[36:39], v[44:47]
    v_cvt_pk_bf16_f32 v48, v32, v33
    v_fma_f32 v34, v34, s38, -v25
    v_mfma_f32_16x16x32_bf16 v[44:47], a[152:155], a[40:43], v[44:47]
    v_exp_f32 v34, v34
    v_mfma_f32_16x16x32_bf16 v[44:47], a[156:159], a[44:47], v[44:47]
    v_fma_f32 v35, v35, s38, -v25
    s_waitcnt lgkmcnt(1)
    v_mfma_f32_16x16x32_bf16 v[64:67], a[192:195], v[52:55], v[64:67]
    v_exp_f32 v35, v35
    v_mfma_f32_16x16x32_bf16 v[68:71], a[196:199], v[52:55], v[68:71]
    v_cvt_pk_bf16_f32 v49, v34, v35
    v_fma_f32 v36, v36, s38, -v25
    v_mfma_f32_16x16x32_bf16 v[72:75], a[200:203], v[52:55], v[72:75]
    v_fma_f32 v37, v37, s38, -v25
    v_exp_f32 v36, v36
    v_mfma_f32_16x16x32_bf16 v[76:79], a[204:207], v[52:55], v[76:79]
    v_exp_f32 v37, v37
    v_mfma_f32_16x16x32_bf16 v[80:83], a[208:211], v[52:55], v[80:83]
    v_cvt_pk_bf16_f32 v50, v36, v37
    v_fma_f32 v38, v38, s38, -v25
    v_mfma_f32_16x16x32_bf16 v[84:87], a[212:215], v[52:55], v[84:87]
    v_fma_f32 v39, v39, s38, -v25
    v_exp_f32 v38, v38
    v_mfma_f32_16x16x32_bf16 v[88:91], a[216:219], v[52:55], v[88:91]
    v_exp_f32 v39, v39
    v_mfma_f32_16x16x32_bf16 v[92:95], a[220:223], v[52:55], v[92:95]
    v_cvt_pk_bf16_f32 v51, v38, v39
    v_fma_f32 v40, v40, s38, -v26
    v_mfma_f32_16x16x32_bf16 a[224:227], a[248:251], v[52:55], a[224:227]
    v_fma_f32 v41, v41, s38, -v26
    v_exp_f32 v40, v40
    v_mfma_f32_16x16x32_bf16 v[32:35], a[96:99], a[48:51], 0
    v_exp_f32 v41, v41
    v_mfma_f32_16x16x32_bf16 v[32:35], a[100:103], a[52:55], v[32:35]
    v_cvt_pk_bf16_f32 v52, v40, v41
    v_fma_f32 v42, v42, s38, -v26
    v_fma_f32 v43, v43, s38, -v26
    v_mfma_f32_16x16x32_bf16 v[32:35], a[104:107], a[56:59], v[32:35]
    v_exp_f32 v42, v42
    v_exp_f32 v43, v43
    v_mfma_f32_16x16x32_bf16 v[32:35], a[108:111], a[60:63], v[32:35]
    v_accvgpr_read_b32 v21, a224
    v_rcp_f32 v20, v21
    v_subrev_u32 v21, s50, v21
    v_cmp_le_u32 vcc, s51, v21
    v_pk_mul_f32 v[64:65], v[64:65], v[20:21] op_sel_hi:[1,0]
    v_pk_mul_f32 v[66:67], v[66:67], v[20:21] op_sel_hi:[1,0]
    v_pk_mul_f32 v[68:69], v[68:69], v[20:21] op_sel_hi:[1,0]
    v_pk_mul_f32 v[70:71], v[70:71], v[20:21] op_sel_hi:[1,0]
    v_pk_mul_f32 v[72:73], v[72:73], v[20:21] op_sel_hi:[1,0]
    v_pk_mul_f32 v[74:75], v[74:75], v[20:21] op_sel_hi:[1,0]
    v_pk_mul_f32 v[76:77], v[76:77], v[20:21] op_sel_hi:[1,0]
    v_pk_mul_f32 v[78:79], v[78:79], v[20:21] op_sel_hi:[1,0]
    v_pk_mul_f32 v[80:81], v[80:81], v[20:21] op_sel_hi:[1,0]
    v_pk_mul_f32 v[82:83], v[82:83], v[20:21] op_sel_hi:[1,0]
    v_pk_mul_f32 v[84:85], v[84:85], v[20:21] op_sel_hi:[1,0]
    v_pk_mul_f32 v[86:87], v[86:87], v[20:21] op_sel_hi:[1,0]
    v_pk_mul_f32 v[88:89], v[88:89], v[20:21] op_sel_hi:[1,0]
    v_pk_mul_f32 v[90:91], v[90:91], v[20:21] op_sel_hi:[1,0]
    v_pk_mul_f32 v[92:93], v[92:93], v[20:21] op_sel_hi:[1,0]
    v_pk_mul_f32 v[94:95], v[94:95], v[20:21] op_sel_hi:[1,0]
    s_or_b64 s[46:47], s[46:47], vcc
    v_cvt_pk_bf16_f32 v64, v64, v65
    v_cvt_pk_bf16_f32 v65, v66, v67
    v_cvt_pk_bf16_f32 v66, v68, v69
    v_cvt_pk_bf16_f32 v67, v70, v71
    v_cvt_pk_bf16_f32 v68, v72, v73
    v_cvt_pk_bf16_f32 v69, v74, v75
    v_cvt_pk_bf16_f32 v70, v76, v77
    v_cvt_pk_bf16_f32 v71, v78, v79
    v_cvt_pk_bf16_f32 v72, v80, v81
    v_cvt_pk_bf16_f32 v73, v82, v83
    v_cvt_pk_bf16_f32 v74, v84, v85
    v_cvt_pk_bf16_f32 v75, v86, v87
    v_cvt_pk_bf16_f32 v76, v88, v89
    v_cvt_pk_bf16_f32 v77, v90, v91
    v_cvt_pk_bf16_f32 v78, v92, v93
    v_cvt_pk_bf16_f32 v79, v94, v95
    v_cvt_pk_bf16_f32 v53, v42, v43
    v_mfma_f32_16x16x32_bf16 v[36:39], a[112:115], a[48:51], 0
    ds_write_b64 v56, v[64:65] offset:0
    v_mfma_f32_16x16x32_bf16 v[36:39], a[116:119], a[52:55], v[36:39]
    ds_write_b64 v57, v[66:67] offset:0
    v_fma_f32 v44, v44, s38, -v26
    v_mfma_f32_16x16x32_bf16 v[36:39], a[120:123], a[56:59], v[36:39]
    v_exp_f32 v44, v44
    v_mfma_f32_16x16x32_bf16 v[36:39], a[124:127], a[60:63], v[36:39]
    ds_write_b64 v58, v[68:69] offset:0
    v_mfma_f32_16x16x32_bf16 v[96:99], a[192:195], v[48:51], v[96:99]
    ds_write_b64 v59, v[70:71] offset:0
    v_fma_f32 v45, v45, s38, -v26
    v_mfma_f32_16x16x32_bf16 v[100:103], a[196:199], v[48:51], v[100:103]
    v_exp_f32 v45, v45
    v_mfma_f32_16x16x32_bf16 v[104:107], a[200:203], v[48:51], v[104:107]
    ds_write_b64 v60, v[72:73] offset:0
    v_cvt_pk_bf16_f32 v54, v44, v45
    v_mfma_f32_16x16x32_bf16 v[108:111], a[204:207], v[48:51], v[108:111]
    ds_write_b64 v61, v[74:75] offset:0
    v_mfma_f32_16x16x32_bf16 v[112:115], a[208:211], v[48:51], v[112:115]
    v_fma_f32 v46, v46, s38, -v26
    v_fma_f32 v47, v47, s38, -v26
    v_mfma_f32_16x16x32_bf16 v[116:119], a[212:215], v[48:51], v[116:119]
    ds_write_b64 v62, v[76:77] offset:0
    v_exp_f32 v46, v46
    v_exp_f32 v47, v47
    v_mfma_f32_16x16x32_bf16 v[120:123], a[216:219], v[48:51], v[120:123]
    ds_write_b64 v63, v[78:79] offset:0
    v_cvt_pk_bf16_f32 v55, v46, v47
    v_mfma_f32_16x16x32_bf16 v[124:127], a[220:223], v[48:51], v[124:127]
    ds_read_b128 v[80:83], v1 offset:0
    ds_read_b128 v[84:87], v1 offset:1024
    v_mfma_f32_16x16x32_bf16 a[228:231], a[248:251], v[48:51], a[228:231]
    ds_read_b128 v[88:91], v1 offset:2048
    ds_read_b128 v[92:95], v1 offset:3072
    v_mfma_f32_16x16x32_bf16 v[40:43], a[128:131], a[48:51], 0
    v_fma_f32 v32, v32, s38, -v27
    v_fma_f32 v33, v33, s38, -v27
    v_mfma_f32_16x16x32_bf16 v[40:43], a[132:135], a[52:55], v[40:43]
    v_exp_f32 v32, v32
    v_exp_f32 v33, v33
    v_mfma_f32_16x16x32_bf16 v[40:43], a[136:139], a[56:59], v[40:43]
    s_add_u32 s43, s40, 0
    s_waitcnt lgkmcnt(0)
    buffer_store_dwordx4 v[80:83], v22, s[12:15], s43 offen offset:0 sc1 nt
    v_cvt_pk_bf16_f32 v48, v32, v33
    v_mfma_f32_16x16x32_bf16 v[40:43], a[140:143], a[60:63], v[40:43]
    v_accvgpr_read_b32 v21, a228
    v_rcp_f32 v20, v21
    v_subrev_u32 v21, s50, v21
    v_cmp_le_u32 vcc, s51, v21
    v_pk_mul_f32 v[96:97], v[96:97], v[20:21] op_sel_hi:[1,0]
    v_pk_mul_f32 v[98:99], v[98:99], v[20:21] op_sel_hi:[1,0]
    v_pk_mul_f32 v[100:101], v[100:101], v[20:21] op_sel_hi:[1,0]
    v_pk_mul_f32 v[102:103], v[102:103], v[20:21] op_sel_hi:[1,0]
    v_pk_mul_f32 v[104:105], v[104:105], v[20:21] op_sel_hi:[1,0]
    v_pk_mul_f32 v[106:107], v[106:107], v[20:21] op_sel_hi:[1,0]
    v_pk_mul_f32 v[108:109], v[108:109], v[20:21] op_sel_hi:[1,0]
    v_pk_mul_f32 v[110:111], v[110:111], v[20:21] op_sel_hi:[1,0]
    v_pk_mul_f32 v[112:113], v[112:113], v[20:21] op_sel_hi:[1,0]
    v_pk_mul_f32 v[114:115], v[114:115], v[20:21] op_sel_hi:[1,0]
    v_pk_mul_f32 v[116:117], v[116:117], v[20:21] op_sel_hi:[1,0]
    v_pk_mul_f32 v[118:119], v[118:119], v[20:21] op_sel_hi:[1,0]
    v_pk_mul_f32 v[120:121], v[120:121], v[20:21] op_sel_hi:[1,0]
    v_pk_mul_f32 v[122:123], v[122:123], v[20:21] op_sel_hi:[1,0]
    v_pk_mul_f32 v[124:125], v[124:125], v[20:21] op_sel_hi:[1,0]
    v_pk_mul_f32 v[126:127], v[126:127], v[20:21] op_sel_hi:[1,0]
    s_or_b64 s[46:47], s[46:47], vcc
    v_cvt_pk_bf16_f32 v96, v96, v97
    v_cvt_pk_bf16_f32 v97, v98, v99
    v_cvt_pk_bf16_f32 v98, v100, v101
    v_cvt_pk_bf16_f32 v99, v102, v103
    v_cvt_pk_bf16_f32 v100, v104, v105
    v_cvt_pk_bf16_f32 v101, v106, v107
    v_cvt_pk_bf16_f32 v102, v108, v109
    v_cvt_pk_bf16_f32 v103, v110, v111
    v_cvt_pk_bf16_f32 v104, v112, v113
    v_cvt_pk_bf16_f32 v105, v114, v115
    v_cvt_pk_bf16_f32 v106, v116, v117
    v_cvt_pk_bf16_f32 v107, v118, v119
    v_cvt_pk_bf16_f32 v108, v120, v121
    v_cvt_pk_bf16_f32 v109, v122, v123
    v_cvt_pk_bf16_f32 v110, v124, v125
    v_cvt_pk_bf16_f32 v111, v126, v127
    v_mfma_f32_16x16x32_bf16 v[44:47], a[144:147], a[48:51], 0
    ds_write_b64 v56, v[96:97] offset:4096
    v_mfma_f32_16x16x32_bf16 v[44:47], a[148:151], a[52:55], v[44:47]
    ds_write_b64 v57, v[98:99] offset:4096
    v_mfma_f32_16x16x32_bf16 v[44:47], a[152:155], a[56:59], v[44:47]
    buffer_store_dwordx4 v[84:87], v23, s[12:15], s43 offen offset:1024 sc1 nt
    v_mfma_f32_16x16x32_bf16 v[44:47], a[156:159], a[60:63], v[44:47]
    ds_write_b64 v58, v[100:101] offset:4096
    v_mfma_f32_16x16x32_bf16 v[128:131], a[192:195], v[52:55], v[128:131]
    ds_write_b64 v59, v[102:103] offset:4096
    v_mfma_f32_16x16x32_bf16 v[132:135], a[196:199], v[52:55], v[132:135]
    v_fma_f32 v34, v34, s38, -v27
    v_fma_f32 v35, v35, s38, -v27
    v_mfma_f32_16x16x32_bf16 v[136:139], a[200:203], v[52:55], v[136:139]
    buffer_store_dwordx4 v[88:91], v22, s[12:15], s43 offen offset:2048 sc1 nt
    ds_write_b64 v60, v[104:105] offset:4096
    v_exp_f32 v34, v34
    v_exp_f32 v35, v35
    v_mfma_f32_16x16x32_bf16 v[140:143], a[204:207], v[52:55], v[140:143]
    ds_write_b64 v61, v[106:107] offset:4096
    v_cvt_pk_bf16_f32 v49, v34, v35
    v_mfma_f32_16x16x32_bf16 v[144:147], a[208:211], v[52:55], v[144:147]
    v_fma_f32 v36, v36, s38, -v27
    v_fma_f32 v37, v37, s38, -v27
    v_mfma_f32_16x16x32_bf16 v[148:151], a[212:215], v[52:55], v[148:151]
    ds_write_b64 v62, v[108:109] offset:4096
    v_exp_f32 v36, v36
    v_exp_f32 v37, v37
    v_mfma_f32_16x16x32_bf16 v[152:155], a[216:219], v[52:55], v[152:155]
    buffer_store_dwordx4 v[92:95], v23, s[12:15], s43 offen offset:3072 sc1 nt
    ds_write_b64 v63, v[110:111] offset:4096
    v_cvt_pk_bf16_f32 v50, v36, v37
    v_mfma_f32_16x16x32_bf16 v[156:159], a[220:223], v[52:55], v[156:159]
    ds_read_b128 v[112:115], v1 offset:4096
    ds_read_b128 v[116:119], v1 offset:5120
    v_mfma_f32_16x16x32_bf16 a[232:235], a[248:251], v[52:55], a[232:235]
    ds_read_b128 v[120:123], v1 offset:6144
    ds_read_b128 v[124:127], v1 offset:7168
    v_mfma_f32_16x16x32_bf16 v[32:35], a[96:99], a[64:67], 0
    v_fma_f32 v38, v38, s38, -v27
    v_fma_f32 v39, v39, s38, -v27
    v_mfma_f32_16x16x32_bf16 v[32:35], a[100:103], a[68:71], v[32:35]
    v_exp_f32 v38, v38
    v_exp_f32 v39, v39
    v_mfma_f32_16x16x32_bf16 v[32:35], a[104:107], a[72:75], v[32:35]
    s_add_u32 s43, s40, 4096
    s_waitcnt lgkmcnt(0)
    buffer_store_dwordx4 v[112:115], v22, s[12:15], s43 offen offset:0 sc1 nt
    v_cvt_pk_bf16_f32 v51, v38, v39
    v_mfma_f32_16x16x32_bf16 v[32:35], a[108:111], a[76:79], v[32:35]
    v_accvgpr_read_b32 v21, a232
    v_rcp_f32 v20, v21
    v_subrev_u32 v21, s50, v21
    v_cmp_le_u32 vcc, s51, v21
    v_pk_mul_f32 v[128:129], v[128:129], v[20:21] op_sel_hi:[1,0]
    v_pk_mul_f32 v[130:131], v[130:131], v[20:21] op_sel_hi:[1,0]
    v_pk_mul_f32 v[132:133], v[132:133], v[20:21] op_sel_hi:[1,0]
    v_pk_mul_f32 v[134:135], v[134:135], v[20:21] op_sel_hi:[1,0]
    v_pk_mul_f32 v[136:137], v[136:137], v[20:21] op_sel_hi:[1,0]
    v_pk_mul_f32 v[138:139], v[138:139], v[20:21] op_sel_hi:[1,0]
    v_pk_mul_f32 v[140:141], v[140:141], v[20:21] op_sel_hi:[1,0]
    v_pk_mul_f32 v[142:143], v[142:143], v[20:21] op_sel_hi:[1,0]
    v_pk_mul_f32 v[144:145], v[144:145], v[20:21] op_sel_hi:[1,0]
    v_pk_mul_f32 v[146:147], v[146:147], v[20:21] op_sel_hi:[1,0]
    v_pk_mul_f32 v[148:149], v[148:149], v[20:21] op_sel_hi:[1,0]
    v_pk_mul_f32 v[150:151], v[150:151], v[20:21] op_sel_hi:[1,0]
    v_pk_mul_f32 v[152:153], v[152:153], v[20:21] op_sel_hi:[1,0]
    v_pk_mul_f32 v[154:155], v[154:155], v[20:21] op_sel_hi:[1,0]
    v_pk_mul_f32 v[156:157], v[156:157], v[20:21] op_sel_hi:[1,0]
    v_pk_mul_f32 v[158:159], v[158:159], v[20:21] op_sel_hi:[1,0]
    s_or_b64 s[46:47], s[46:47], vcc
    v_cvt_pk_bf16_f32 v128, v128, v129
    v_cvt_pk_bf16_f32 v129, v130, v131
    v_cvt_pk_bf16_f32 v130, v132, v133
    v_cvt_pk_bf16_f32 v131, v134, v135
    v_cvt_pk_bf16_f32 v132, v136, v137
    v_cvt_pk_bf16_f32 v133, v138, v139
    v_cvt_pk_bf16_f32 v134, v140, v141
    v_cvt_pk_bf16_f32 v135, v142, v143
    v_cvt_pk_bf16_f32 v136, v144, v145
    v_cvt_pk_bf16_f32 v137, v146, v147
    v_cvt_pk_bf16_f32 v138, v148, v149
    v_cvt_pk_bf16_f32 v139, v150, v151
    v_cvt_pk_bf16_f32 v140, v152, v153
    v_cvt_pk_bf16_f32 v141, v154, v155
    v_cvt_pk_bf16_f32 v142, v156, v157
    v_cvt_pk_bf16_f32 v143, v158, v159
    v_mfma_f32_16x16x32_bf16 v[36:39], a[112:115], a[64:67], 0
    ds_write_b64 v56, v[128:129] offset:0
    v_mfma_f32_16x16x32_bf16 v[36:39], a[116:119], a[68:71], v[36:39]
    ds_write_b64 v57, v[130:131] offset:0
    v_mfma_f32_16x16x32_bf16 v[36:39], a[120:123], a[72:75], v[36:39]
    buffer_store_dwordx4 v[116:119], v23, s[12:15], s43 offen offset:1024 sc1 nt
    v_mfma_f32_16x16x32_bf16 v[36:39], a[124:127], a[76:79], v[36:39]
    ds_write_b64 v58, v[132:133] offset:0
    v_mfma_f32_16x16x32_bf16 v[160:163], a[160:163], v[48:51], v[160:163]
    ds_write_b64 v59, v[134:135] offset:0
    v_mfma_f32_16x16x32_bf16 v[164:167], a[164:167], v[48:51], v[164:167]
    v_fma_f32 v40, v40, s38, -v27
    v_fma_f32 v41, v41, s38, -v27
    v_mfma_f32_16x16x32_bf16 v[168:171], a[168:171], v[48:51], v[168:171]
    buffer_store_dwordx4 v[120:123], v22, s[12:15], s43 offen offset:2048 sc1 nt
    ds_write_b64 v60, v[136:137] offset:0
    v_exp_f32 v40, v40
    v_exp_f32 v41, v41
    v_mfma_f32_16x16x32_bf16 v[172:175], a[172:175], v[48:51], v[172:175]
    ds_write_b64 v61, v[138:139] offset:0
    v_cvt_pk_bf16_f32 v52, v40, v41
    v_mfma_f32_16x16x32_bf16 v[176:179], a[176:179], v[48:51], v[176:179]
    v_fma_f32 v42, v42, s38, -v27
    v_fma_f32 v43, v43, s38, -v27
    v_mfma_f32_16x16x32_bf16 v[180:183], a[180:183], v[48:51], v[180:183]
    ds_write_b64 v62, v[140:141] offset:0
    v_exp_f32 v42, v42
    v_exp_f32 v43, v43
    v_mfma_f32_16x16x32_bf16 v[184:187], a[184:187], v[48:51], v[184:187]
    buffer_store_dwordx4 v[124:127], v23, s[12:15], s43 offen offset:3072 sc1 nt
    ds_write_b64 v63, v[142:143] offset:0
    v_cvt_pk_bf16_f32 v53, v42, v43
    v_mfma_f32_16x16x32_bf16 v[188:191], a[188:191], v[48:51], v[188:191]
    ds_read_b128 v[144:147], v1 offset:0
    ds_read_b128 v[148:151], v1 offset:1024
    v_mfma_f32_16x16x32_bf16 a[236:239], a[248:251], v[48:51], a[236:239]
    ds_read_b128 v[152:155], v1 offset:2048
    ds_read_b128 v[156:159], v1 offset:3072
    v_mfma_f32_16x16x32_bf16 v[40:43], a[128:131], a[64:67], 0
    v_fma_f32 v44, v44, s38, -v27
    v_fma_f32 v45, v45, s38, -v27
    v_mfma_f32_16x16x32_bf16 v[40:43], a[132:135], a[68:71], v[40:43]
    v_fma_f32 v46, v46, s38, -v27
    v_fma_f32 v47, v47, s38, -v27
    v_exp_f32 v44, v44
    v_exp_f32 v45, v45
    v_mfma_f32_16x16x32_bf16 v[40:43], a[136:139], a[72:75], v[40:43]
    v_cvt_pk_bf16_f32 v54, v44, v45
    v_exp_f32 v46, v46
    v_exp_f32 v47, v47
    v_mfma_f32_16x16x32_bf16 v[40:43], a[140:143], a[76:79], v[40:43]
    s_add_u32 s43, s40, 8192
    s_waitcnt lgkmcnt(0)
    buffer_store_dwordx4 v[144:147], v22, s[12:15], s43 offen offset:0 sc1 nt
    v_cvt_pk_bf16_f32 v55, v46, v47
    v_mfma_f32_16x16x32_bf16 v[44:47], a[144:147], a[64:67], 0
    v_fma_f32 v32, v32, s38, -v28
    v_fma_f32 v33, v33, s38, -v28
    v_mfma_f32_16x16x32_bf16 v[44:47], a[148:151], a[68:71], v[44:47]
    v_exp_f32 v32, v32
    v_exp_f32 v33, v33
    v_mfma_f32_16x16x32_bf16 v[44:47], a[152:155], a[72:75], v[44:47]
    v_cvt_pk_bf16_f32 v48, v32, v33
    v_fma_f32 v34, v34, s38, -v28
    v_mfma_f32_16x16x32_bf16 v[44:47], a[156:159], a[76:79], v[44:47]
    v_exp_f32 v34, v34
    v_mfma_f32_16x16x32_bf16 v[160:163], a[192:195], v[52:55], v[160:163]
    buffer_store_dwordx4 v[148:151], v23, s[12:15], s43 offen offset:1024 sc1 nt
    v_fma_f32 v35, v35, s38, -v28
    v_mfma_f32_16x16x32_bf16 v[164:167], a[196:199], v[52:55], v[164:167]
    v_exp_f32 v35, v35
    v_mfma_f32_16x16x32_bf16 v[168:171], a[200:203], v[52:55], v[168:171]
    v_cvt_pk_bf16_f32 v49, v34, v35
    v_fma_f32 v36, v36, s38, -v28
    v_mfma_f32_16x16x32_bf16 v[172:175], a[204:207], v[52:55], v[172:175]
    v_fma_f32 v37, v37, s38, -v28
    v_exp_f32 v36, v36
    v_mfma_f32_16x16x32_bf16 v[176:179], a[208:211], v[52:55], v[176:179]
    v_exp_f32 v37, v37
    v_mfma_f32_16x16x32_bf16 v[180:183], a[212:215], v[52:55], v[180:183]
    buffer_store_dwordx4 v[152:155], v22, s[12:15], s43 offen offset:2048 sc1 nt
    v_cvt_pk_bf16_f32 v50, v36, v37
    v_mfma_f32_16x16x32_bf16 v[184:187], a[216:219], v[52:55], v[184:187]
    v_fma_f32 v38, v38, s38, -v28
    v_fma_f32 v39, v39, s38, -v28
    v_mfma_f32_16x16x32_bf16 v[188:191], a[220:223], v[52:55], v[188:191]
    v_exp_f32 v38, v38
    v_exp_f32 v39, v39
    v_mfma_f32_16x16x32_bf16 a[236:239], a[248:251], v[52:55], a[236:239]
    v_cvt_pk_bf16_f32 v51, v38, v39
    v_fma_f32 v40, v40, s38, -v28
    v_mfma_f32_16x16x32_bf16 v[32:35], a[96:99], a[80:83], 0
    v_exp_f32 v40, v40
    v_mfma_f32_16x16x32_bf16 v[32:35], a[100:103], a[84:87], v[32:35]
    buffer_store_dwordx4 v[156:159], v23, s[12:15], s43 offen offset:3072 sc1 nt
    v_fma_f32 v41, v41, s38, -v28
    v_mfma_f32_16x16x32_bf16 v[32:35], a[104:107], a[88:91], v[32:35]
    v_exp_f32 v41, v41
    v_mfma_f32_16x16x32_bf16 v[32:35], a[108:111], a[92:95], v[32:35]
    v_accvgpr_read_b32 v21, a236
    v_rcp_f32 v20, v21
    v_subrev_u32 v21, s50, v21
    v_cmp_le_u32 vcc, s51, v21
    v_pk_mul_f32 v[160:161], v[160:161], v[20:21] op_sel_hi:[1,0]
    v_pk_mul_f32 v[162:163], v[162:163], v[20:21] op_sel_hi:[1,0]
    v_pk_mul_f32 v[164:165], v[164:165], v[20:21] op_sel_hi:[1,0]
    v_pk_mul_f32 v[166:167], v[166:167], v[20:21] op_sel_hi:[1,0]
    v_pk_mul_f32 v[168:169], v[168:169], v[20:21] op_sel_hi:[1,0]
    v_pk_mul_f32 v[170:171], v[170:171], v[20:21] op_sel_hi:[1,0]
    v_pk_mul_f32 v[172:173], v[172:173], v[20:21] op_sel_hi:[1,0]
    v_pk_mul_f32 v[174:175], v[174:175], v[20:21] op_sel_hi:[1,0]
    v_pk_mul_f32 v[176:177], v[176:177], v[20:21] op_sel_hi:[1,0]
    v_pk_mul_f32 v[178:179], v[178:179], v[20:21] op_sel_hi:[1,0]
    v_pk_mul_f32 v[180:181], v[180:181], v[20:21] op_sel_hi:[1,0]
    v_pk_mul_f32 v[182:183], v[182:183], v[20:21] op_sel_hi:[1,0]
    v_pk_mul_f32 v[184:185], v[184:185], v[20:21] op_sel_hi:[1,0]
    v_pk_mul_f32 v[186:187], v[186:187], v[20:21] op_sel_hi:[1,0]
    v_pk_mul_f32 v[188:189], v[188:189], v[20:21] op_sel_hi:[1,0]
    v_pk_mul_f32 v[190:191], v[190:191], v[20:21] op_sel_hi:[1,0]
    s_or_b64 s[46:47], s[46:47], vcc
    v_cvt_pk_bf16_f32 v160, v160, v161
    v_cvt_pk_bf16_f32 v161, v162, v163
    v_cvt_pk_bf16_f32 v162, v164, v165
    v_cvt_pk_bf16_f32 v163, v166, v167
    v_cvt_pk_bf16_f32 v164, v168, v169
    v_cvt_pk_bf16_f32 v165, v170, v171
    v_cvt_pk_bf16_f32 v166, v172, v173
    v_cvt_pk_bf16_f32 v167, v174, v175
    v_cvt_pk_bf16_f32 v168, v176, v177
    v_cvt_pk_bf16_f32 v169, v178, v179
    v_cvt_pk_bf16_f32 v170, v180, v181
    v_cvt_pk_bf16_f32 v171, v182, v183
    v_cvt_pk_bf16_f32 v172, v184, v185
    v_cvt_pk_bf16_f32 v173, v186, v187
    v_cvt_pk_bf16_f32 v174, v188, v189
    v_cvt_pk_bf16_f32 v175, v190, v191
    v_cvt_pk_bf16_f32 v52, v40, v41
    v_mfma_f32_16x16x32_bf16 v[36:39], a[112:115], a[80:83], 0
    ds_write_b64 v56, v[160:161] offset:4096
    v_mfma_f32_16x16x32_bf16 v[36:39], a[116:119], a[84:87], v[36:39]
    v_fma_f32 v42, v42, s38, -v28
    v_fma_f32 v43, v43, s38, -v28
    v_mfma_f32_16x16x32_bf16 v[36:39], a[120:123], a[88:91], v[36:39]
    ds_write_b64 v57, v[162:163] offset:4096
    v_exp_f32 v42, v42
    v_exp_f32 v43, v43
    v_mfma_f32_16x16x32_bf16 v[36:39], a[124:127], a[92:95], v[36:39]
    v_cvt_pk_bf16_f32 v53, v42, v43
    v_fma_f32 v44, v44, s38, -v28
    v_mfma_f32_16x16x32_bf16 v[192:195], a[160:163], v[48:51], v[192:195]
    ds_write_b64 v58, v[164:165] offset:4096
    v_mfma_f32_16x16x32_bf16 v[196:199], a[164:167], v[48:51], v[196:199]
    v_exp_f32 v44, v44
    v_mfma_f32_16x16x32_bf16 v[200:203], a[168:171], v[48:51], v[200:203]
    ds_write_b64 v59, v[166:167] offset:4096
    v_fma_f32 v45, v45, s38, -v28
    v_mfma_f32_16x16x32_bf16 v[204:207], a[172:175], v[48:51], v[204:207]
    v_exp_f32 v45, v45
    v_mfma_f32_16x16x32_bf16 v[208:211], a[176:179], v[48:51], v[208:211]
    ds_write_b64 v60, v[168:169] offset:4096
    v_cvt_pk_bf16_f32 v54, v44, v45
    v_mfma_f32_16x16x32_bf16 v[212:215], a[180:183], v[48:51], v[212:215]
    v_fma_f32 v46, v46, s38, -v28
    v_fma_f32 v47, v47, s38, -v28
    v_mfma_f32_16x16x32_bf16 v[216:219], a[184:187], v[48:51], v[216:219]
    ds_write_b64 v61, v[170:171] offset:4096
    v_exp_f32 v46, v46
    v_exp_f32 v47, v47
    v_mfma_f32_16x16x32_bf16 v[220:223], a[188:191], v[48:51], v[220:223]
    v_cvt_pk_bf16_f32 v55, v46, v47
    v_fma_f32 v32, v32, s38, -v29
    v_mfma_f32_16x16x32_bf16 a[240:243], a[248:251], v[48:51], a[240:243]
    ds_write_b64 v62, v[172:173] offset:4096
    v_fma_f32 v33, v33, s38, -v29
    v_mfma_f32_16x16x32_bf16 v[40:43], a[128:131], a[80:83], 0
    v_exp_f32 v32, v32
    v_exp_f32 v33, v33
    v_mfma_f32_16x16x32_bf16 v[40:43], a[132:135], a[84:87], v[40:43]
    ds_write_b64 v63, v[174:175] offset:4096
    v_cvt_pk_bf16_f32 v48, v32, v33
    v_mfma_f32_16x16x32_bf16 v[40:43], a[136:139], a[88:91], v[40:43]
    ds_read_b128 v[176:179], v1 offset:4096
    ds_read_b128 v[180:183], v1 offset:5120
    v_mfma_f32_16x16x32_bf16 v[40:43], a[140:143], a[92:95], v[40:43]
    ds_read_b128 v[184:187], v1 offset:6144
    ds_read_b128 v[188:191], v1 offset:7168
    v_mfma_f32_16x16x32_bf16 v[44:47], a[144:147], a[80:83], 0
    v_fma_f32 v34, v34, s38, -v29
    v_fma_f32 v35, v35, s38, -v29
    v_mfma_f32_16x16x32_bf16 v[44:47], a[148:151], a[84:87], v[44:47]
    v_exp_f32 v34, v34
    v_mfma_f32_16x16x32_bf16 v[44:47], a[152:155], a[88:91], v[44:47]
    v_exp_f32 v35, v35
    v_mfma_f32_16x16x32_bf16 v[44:47], a[156:159], a[92:95], v[44:47]
    s_add_u32 s43, s40, 12288
    s_waitcnt lgkmcnt(0)
    buffer_store_dwordx4 v[176:179], v22, s[12:15], s43 offen offset:0 sc1 nt
    v_cvt_pk_bf16_f32 v49, v34, v35
    v_mfma_f32_16x16x32_bf16 v[192:195], a[192:195], v[52:55], v[192:195]
    v_fma_f32 v36, v36, s38, -v29
    v_fma_f32 v37, v37, s38, -v29
    v_mfma_f32_16x16x32_bf16 v[196:199], a[196:199], v[52:55], v[196:199]
    v_exp_f32 v36, v36
    v_mfma_f32_16x16x32_bf16 v[200:203], a[200:203], v[52:55], v[200:203]
    v_exp_f32 v37, v37
    v_mfma_f32_16x16x32_bf16 v[204:207], a[204:207], v[52:55], v[204:207]
    buffer_store_dwordx4 v[180:183], v23, s[12:15], s43 offen offset:1024 sc1 nt
    v_cvt_pk_bf16_f32 v50, v36, v37
    v_mfma_f32_16x16x32_bf16 v[208:211], a[208:211], v[52:55], v[208:211]
    v_fma_f32 v38, v38, s38, -v29
    v_fma_f32 v39, v39, s38, -v29
    v_mfma_f32_16x16x32_bf16 v[212:215], a[212:215], v[52:55], v[212:215]
    v_exp_f32 v38, v38
    v_exp_f32 v39, v39
    v_mfma_f32_16x16x32_bf16 v[216:219], a[216:219], v[52:55], v[216:219]
    v_cvt_pk_bf16_f32 v51, v38, v39
    v_fma_f32 v40, v40, s38, -v29
    v_fma_f32 v41, v41, s38, -v29
    v_mfma_f32_16x16x32_bf16 v[220:223], a[220:223], v[52:55], v[220:223]
    buffer_store_dwordx4 v[184:187], v22, s[12:15], s43 offen offset:2048 sc1 nt
    v_exp_f32 v40, v40
    v_exp_f32 v41, v41
    v_mfma_f32_16x16x32_bf16 a[240:243], a[248:251], v[52:55], a[240:243]
    v_cvt_pk_bf16_f32 v52, v40, v41
    v_fma_f32 v42, v42, s38, -v29
    v_fma_f32 v43, v43, s38, -v29
    v_mfma_f32_16x16x32_bf16 v[224:227], a[160:163], v[48:51], v[224:227]
    v_exp_f32 v42, v42
    v_exp_f32 v43, v43
    v_mfma_f32_16x16x32_bf16 v[228:231], a[164:167], v[48:51], v[228:231]
    v_cvt_pk_bf16_f32 v53, v42, v43
    v_fma_f32 v44, v44, s38, -v29
    v_fma_f32 v45, v45, s38, -v29
    v_mfma_f32_16x16x32_bf16 v[232:235], a[168:171], v[48:51], v[232:235]
    buffer_store_dwordx4 v[188:191], v23, s[12:15], s43 offen offset:3072 sc1 nt
    v_exp_f32 v44, v44
    v_exp_f32 v45, v45
    v_mfma_f32_16x16x32_bf16 v[236:239], a[172:175], v[48:51], v[236:239]
    v_accvgpr_read_b32 v21, a240
    v_rcp_f32 v20, v21
    v_subrev_u32 v21, s50, v21
    v_cmp_le_u32 vcc, s51, v21
    v_pk_mul_f32 v[192:193], v[192:193], v[20:21] op_sel_hi:[1,0]
    v_pk_mul_f32 v[194:195], v[194:195], v[20:21] op_sel_hi:[1,0]
    v_pk_mul_f32 v[196:197], v[196:197], v[20:21] op_sel_hi:[1,0]
    v_pk_mul_f32 v[198:199], v[198:199], v[20:21] op_sel_hi:[1,0]
    v_pk_mul_f32 v[200:201], v[200:201], v[20:21] op_sel_hi:[1,0]
    v_pk_mul_f32 v[202:203], v[202:203], v[20:21] op_sel_hi:[1,0]
    v_pk_mul_f32 v[204:205], v[204:205], v[20:21] op_sel_hi:[1,0]
    v_pk_mul_f32 v[206:207], v[206:207], v[20:21] op_sel_hi:[1,0]
    v_pk_mul_f32 v[208:209], v[208:209], v[20:21] op_sel_hi:[1,0]
    v_pk_mul_f32 v[210:211], v[210:211], v[20:21] op_sel_hi:[1,0]
    v_pk_mul_f32 v[212:213], v[212:213], v[20:21] op_sel_hi:[1,0]
    v_pk_mul_f32 v[214:215], v[214:215], v[20:21] op_sel_hi:[1,0]
    v_pk_mul_f32 v[216:217], v[216:217], v[20:21] op_sel_hi:[1,0]
    v_pk_mul_f32 v[218:219], v[218:219], v[20:21] op_sel_hi:[1,0]
    v_pk_mul_f32 v[220:221], v[220:221], v[20:21] op_sel_hi:[1,0]
    v_pk_mul_f32 v[222:223], v[222:223], v[20:21] op_sel_hi:[1,0]
    s_or_b64 s[46:47], s[46:47], vcc
    v_cvt_pk_bf16_f32 v192, v192, v193
    v_cvt_pk_bf16_f32 v193, v194, v195
    v_cvt_pk_bf16_f32 v194, v196, v197
    v_cvt_pk_bf16_f32 v195, v198, v199
    v_cvt_pk_bf16_f32 v196, v200, v201
    v_cvt_pk_bf16_f32 v197, v202, v203
    v_cvt_pk_bf16_f32 v198, v204, v205
    v_cvt_pk_bf16_f32 v199, v206, v207
    v_cvt_pk_bf16_f32 v200, v208, v209
    v_cvt_pk_bf16_f32 v201, v210, v211
    v_cvt_pk_bf16_f32 v202, v212, v213
    v_cvt_pk_bf16_f32 v203, v214, v215
    v_cvt_pk_bf16_f32 v204, v216, v217
    v_cvt_pk_bf16_f32 v205, v218, v219
    v_cvt_pk_bf16_f32 v206, v220, v221
    v_cvt_pk_bf16_f32 v207, v222, v223
    v_cvt_pk_bf16_f32 v54, v44, v45
    v_mfma_f32_16x16x32_bf16 v[240:243], a[176:179], v[48:51], v[240:243]
    ds_write_b64 v56, v[192:193] offset:0
    v_mfma_f32_16x16x32_bf16 v[244:247], a[180:183], v[48:51], v[244:247]
    ds_write_b64 v57, v[194:195] offset:0
    v_fma_f32 v46, v46, s38, -v29
    v_fma_f32 v47, v47, s38, -v29
    v_mfma_f32_16x16x32_bf16 v[248:251], a[184:187], v[48:51], v[248:251]
    ds_write_b64 v58, v[196:197] offset:0
    v_exp_f32 v46, v46
    v_exp_f32 v47, v47
    v_mfma_f32_16x16x32_bf16 v[252:255], a[188:191], v[48:51], v[252:255]
    ds_write_b64 v59, v[198:199] offset:0
    v_cvt_pk_bf16_f32 v55, v46, v47
    v_mfma_f32_16x16x32_bf16 a[244:247], a[248:251], v[48:51], a[244:247]
    ds_write_b64 v60, v[200:201] offset:0
    v_mfma_f32_16x16x32_bf16 a[244:247], a[248:251], v[52:55], a[244:247]
    ds_write_b64 v61, v[202:203] offset:0
    v_mfma_f32_16x16x32_bf16 v[224:227], a[192:195], v[52:55], v[224:227]
    ds_write_b64 v62, v[204:205] offset:0
    v_mfma_f32_16x16x32_bf16 v[228:231], a[196:199], v[52:55], v[228:231]
    ds_write_b64 v63, v[206:207] offset:0
    v_mfma_f32_16x16x32_bf16 v[232:235], a[200:203], v[52:55], v[232:235]
    ds_read_b128 v[208:211], v1 offset:0
    ds_read_b128 v[212:215], v1 offset:1024
    v_mfma_f32_16x16x32_bf16 v[236:239], a[204:207], v[52:55], v[236:239]
    ds_read_b128 v[216:219], v1 offset:2048
    ds_read_b128 v[220:223], v1 offset:3072
    v_mfma_f32_16x16x32_bf16 v[240:243], a[208:211], v[52:55], v[240:243]
    v_mfma_f32_16x16x32_bf16 v[244:247], a[212:215], v[52:55], v[244:247]
    v_mfma_f32_16x16x32_bf16 v[248:251], a[216:219], v[52:55], v[248:251]
    v_mfma_f32_16x16x32_bf16 v[252:255], a[220:223], v[52:55], v[252:255]
    v_accvgpr_read_b32 v21, a244
    v_rcp_f32 v20, v21
    v_subrev_u32 v21, s50, v21
    v_cmp_le_u32 vcc, s51, v21
    s_add_u32 s43, s40, 16384
    s_waitcnt lgkmcnt(0)
    buffer_store_dwordx4 v[208:211], v22, s[12:15], s43 offen offset:0 sc1 nt
    v_pk_mul_f32 v[224:225], v[224:225], v[20:21] op_sel_hi:[1,0]
    v_pk_mul_f32 v[226:227], v[226:227], v[20:21] op_sel_hi:[1,0]
    v_pk_mul_f32 v[228:229], v[228:229], v[20:21] op_sel_hi:[1,0]
    v_pk_mul_f32 v[230:231], v[230:231], v[20:21] op_sel_hi:[1,0]
    v_pk_mul_f32 v[232:233], v[232:233], v[20:21] op_sel_hi:[1,0]
    v_pk_mul_f32 v[234:235], v[234:235], v[20:21] op_sel_hi:[1,0]
    v_pk_mul_f32 v[236:237], v[236:237], v[20:21] op_sel_hi:[1,0]
    v_pk_mul_f32 v[238:239], v[238:239], v[20:21] op_sel_hi:[1,0]
    v_cvt_pk_bf16_f32 v224, v224, v225
    v_cvt_pk_bf16_f32 v225, v226, v227
    v_cvt_pk_bf16_f32 v226, v228, v229
    v_cvt_pk_bf16_f32 v227, v230, v231
    v_cvt_pk_bf16_f32 v228, v232, v233
    v_cvt_pk_bf16_f32 v229, v234, v235
    v_cvt_pk_bf16_f32 v230, v236, v237
    v_cvt_pk_bf16_f32 v231, v238, v239
    buffer_store_dwordx4 v[212:215], v23, s[12:15], s43 offen offset:1024 sc1 nt
    ds_write_b64 v56, v[224:225] offset:4096
    ds_write_b64 v57, v[226:227] offset:4096
    ds_write_b64 v58, v[228:229] offset:4096
    ds_write_b64 v59, v[230:231] offset:4096
    buffer_store_dwordx4 v[216:219], v22, s[12:15], s43 offen offset:2048 sc1 nt
    v_pk_mul_f32 v[240:241], v[240:241], v[20:21] op_sel_hi:[1,0]
    v_pk_mul_f32 v[242:243], v[242:243], v[20:21] op_sel_hi:[1,0]
    v_pk_mul_f32 v[244:245], v[244:245], v[20:21] op_sel_hi:[1,0]
    v_pk_mul_f32 v[246:247], v[246:247], v[20:21] op_sel_hi:[1,0]
    v_pk_mul_f32 v[248:249], v[248:249], v[20:21] op_sel_hi:[1,0]
    v_pk_mul_f32 v[250:251], v[250:251], v[20:21] op_sel_hi:[1,0]
    v_pk_mul_f32 v[252:253], v[252:253], v[20:21] op_sel_hi:[1,0]
    v_pk_mul_f32 v[254:255], v[254:255], v[20:21] op_sel_hi:[1,0]
    v_cvt_pk_bf16_f32 v232, v240, v241
    v_cvt_pk_bf16_f32 v233, v242, v243
    v_cvt_pk_bf16_f32 v234, v244, v245
    v_cvt_pk_bf16_f32 v235, v246, v247
    v_cvt_pk_bf16_f32 v236, v248, v249
    v_cvt_pk_bf16_f32 v237, v250, v251
    v_cvt_pk_bf16_f32 v238, v252, v253
    v_cvt_pk_bf16_f32 v239, v254, v255
    buffer_store_dwordx4 v[220:223], v23, s[12:15], s43 offen offset:3072 sc1 nt
    ds_write_b64 v60, v[232:233] offset:4096
    ds_write_b64 v61, v[234:235] offset:4096
    ds_write_b64 v62, v[236:237] offset:4096
    ds_write_b64 v63, v[238:239] offset:4096
    ds_read_b128 v[240:243], v1 offset:4096
    ds_read_b128 v[244:247], v1 offset:5120
    ds_read_b128 v[248:251], v1 offset:6144
    ds_read_b128 v[252:255], v1 offset:7168
    s_or_b64 s[46:47], s[46:47], vcc
    s_cmp_lg_u64 s[46:47], 0
    s_cselect_b32 s39, 2, 0
    s_or_b32 s48, s48, s39
    s_add_u32 s43, s40, 20480
    s_waitcnt lgkmcnt(3)
    buffer_store_dwordx4 v[240:243], v22, s[12:15], s43 offen offset:0 sc1 nt
    s_waitcnt lgkmcnt(2)
    buffer_store_dwordx4 v[244:247], v23, s[12:15], s43 offen offset:1024 sc1 nt
    s_waitcnt lgkmcnt(1)
    buffer_store_dwordx4 v[248:251], v22, s[12:15], s43 offen offset:2048 sc1 nt
    s_waitcnt lgkmcnt(0)
    buffer_store_dwordx4 v[252:255], v23, s[12:15], s43 offen offset:3072 sc1 nt
    s_cmp_eq_u32 s48, 0
    s_cbranch_scc1 L_end
L_fallback:
    s_waitcnt vmcnt(0) lgkmcnt(0)
    s_mov_b32 s37, 0
    v_mbcnt_lo_u32_b32 v22, -1, 0
    v_mbcnt_hi_u32_b32 v22, -1, v22
    v_and_b32 v23, 15, v22
    v_lshrrev_b32 v24, 4, v22
    v_lshlrev_b32 v25, 4, v24
    v_lshl_add_u32 v21, v23, 8, v25
    v_lshlrev_b32 v25, 3, v24
    v_lshl_add_u32 v4, v23, 8, v25
    s_add_u32 s39, s98, 98304
    v_lshrrev_b32 v24, 2, v22
    v_and_b32 v25, 7, v24
    v_lshlrev_b32 v25, 5, v25
    v_lshl_add_u32 v25, v24, 8, v25
    v_and_b32 v26, 3, v22
    v_lshl_add_u32 v25, v26, 3, v25
    v_add_u32 v8, s39, v25
    v_xor_b32 v9, 32, v8
    v_xor_b32 v10, 64, v8
    v_xor_b32 v11, 96, v8
    v_xor_b32 v12, 128, v8
    v_xor_b32 v13, 160, v8
    v_xor_b32 v14, 192, v8
    v_xor_b32 v15, 224, v8
L_fb_head:
    s_bitcmp1_b32 s48, s37
    s_cbranch_scc0 L_fb_nexthead
    s_mov_b32 s33, 0
L_fb_qb:
    s_mul_i32 s40, s37, 98304
    s_add_u32 s40, s40, s54
    s_lshl_b32 s39, s33, 12
    s_add_u32 s40, s40, s39
    buffer_load_dwordx4 a[0:3], v21, s[16:19], s40 offen offset:0
    buffer_load_dwordx4 a[4:7], v21, s[16:19], s40 offen offset:64
    buffer_load_dwordx4 a[8:11], v21, s[16:19], s40 offen offset:128
    buffer_load_dwordx4 a[12:15], v21, s[16:19], s40 offen offset:192
    v_mov_b32 v16, 0xff800000
    v_mov_b32 v17, 0
    v_mov_b32 v64, 0
    v_mov_b32 v65, 0
    v_mov_b32 v66, 0
    v_mov_b32 v67, 0
    v_mov_b32 v68, 0
    v_mov_b32 v69, 0
    v_mov_b32 v70, 0
    v_mov_b32 v71, 0
    v_mov_b32 v72, 0
    v_mov_b32 v73, 0
    v_mov_b32 v74, 0
    v_mov_b32 v75, 0
    v_mov_b32 v76, 0
    v_mov_b32 v77, 0
    v_mov_b32 v78, 0
    v_mov_b32 v79, 0
    v_mov_b32 v80, 0
    v_mov_b32 v81, 0
    v_mov_b32 v82, 0
    v_mov_b32 v83, 0
    v_mov_b32 v84, 0
    v_mov_b32 v85, 0
    v_mov_b32 v86, 0
    v_mov_b32 v87, 0
    v_mov_b32 v88, 0
    v_mov_b32 v89, 0
    v_mov_b32 v90, 0
    v_mov_b32 v91, 0
    v_mov_b32 v92, 0
    v_mov_b32 v93, 0
    v_mov_b32 v94, 0
    v_mov_b32 v95, 0
    s_lshl_b32 s30, s37, 17
    s_add_u32 s30, s30, s55
    s_lshl_b32 s39, s28, 12
    s_sub_u32 s30, s30, s39
    s_mov_b32 s56, 0
L_fb_j:
    s_add_u32 s31, s30, 4096
    buffer_load_dwordx4 a[96:99], v21, s[20:23], s30 offen offset:0
    buffer_load_dwordx4 a[100:103], v21, s[20:23], s30 offen offset:64
    buffer_load_dwordx4 a[104:107], v21, s[20:23], s30 offen offset:128
    buffer_load_dwordx4 a[108:111], v21, s[20:23], s30 offen offset:192
    buffer_load_dwordx4 a[112:115], v21, s[20:23], s31 offen offset:0
    buffer_load_dwordx4 a[116:119], v21, s[20:23], s31 offen offset:64
    buffer_load_dwordx4 a[120:123], v21, s[20:23], s31 offen offset:128
    buffer_load_dwordx4 a[124:127], v21, s[20:23], s31 offen offset:192
    s_add_u32 m0, s98, 98304
    s_nop 0
    buffer_load_dwordx4 v2, s[24:27], s30 offen offset:0 lds
    buffer_load_dwordx4 v3, s[24:27], s30 offen offset:1024 lds
    buffer_load_dwordx4 v2, s[24:27], s30 offen offset:2048 lds
    buffer_load_dwordx4 v3, s[24:27], s30 offen offset:3072 lds
    s_add_u32 m0, m0, 4096
    s_nop 0
    buffer_load_dwordx4 v2, s[24:27], s31 offen offset:0 lds
    buffer_load_dwordx4 v3, s[24:27], s31 offen offset:1024 lds
    buffer_load_dwordx4 v2, s[24:27], s31 offen offset:2048 lds
    buffer_load_dwordx4 v3, s[24:27], s31 offen offset:3072 lds
    s_waitcnt vmcnt(0)
    ds_read_b64_tr_b16 a[160:161], v8 offset:0
    ds_read_b64_tr_b16 a[162:163], v8 offset:4096
    ds_read_b64_tr_b16 a[164:165], v9 offset:0
    ds_read_b64_tr_b16 a[166:167], v9 offset:4096
    ds_read_b64_tr_b16 a[168:169], v10 offset:0
    ds_read_b64_tr_b16 a[170:171], v10 offset:4096
    ds_read_b64_tr_b16 a[172:173], v11 offset:0
    ds_read_b64_tr_b16 a[174:175], v11 offset:4096
    ds_read_b64_tr_b16 a[176:177], v12 offset:0
    ds_read_b64_tr_b16 a[178:179], v12 offset:4096
    ds_read_b64_tr_b16 a[180:181], v13 offset:0
    ds_read_b64_tr_b16 a[182:183], v13 offset:4096
    ds_read_b64_tr_b16 a[184:185], v14 offset:0
    ds_read_b64_tr_b16 a[186:187], v14 offset:4096
    ds_read_b64_tr_b16 a[188:189], v15 offset:0
    ds_read_b64_tr_b16 a[190:191], v15 offset:4096
    v_mfma_f32_16x16x32_bf16 v[32:35], a[96:99], a[0:3], 0
    v_mfma_f32_16x16x32_bf16 v[32:35], a[100:103], a[4:7], v[32:35]
    v_mfma_f32_16x16x32_bf16 v[32:35], a[104:107], a[8:11], v[32:35]
    v_mfma_f32_16x16x32_bf16 v[32:35], a[108:111], a[12:15], v[32:35]
    v_mfma_f32_16x16x32_bf16 v[36:39], a[112:115], a[0:3], 0
    v_mfma_f32_16x16x32_bf16 v[36:39], a[116:119], a[4:7], v[36:39]
    v_mfma_f32_16x16x32_bf16 v[36:39], a[120:123], a[8:11], v[36:39]
    v_mfma_f32_16x16x32_bf16 v[36:39], a[124:127], a[12:15], v[36:39]
    s_nop 3
    v_max3_f32 v19, v32, v33, v34
    s_nop 2
    v_max3_f32 v19, v19, v35, v36
    v_max3_f32 v19, v19, v37, v38
    v_max3_f32 v19, v19, v39, v16
    v_mov_b32 v20, v19
    s_nop 1
    v_permlane32_swap_b32 v19, v20
    v_max_f32 v19, v19, v20
    v_mov_b32 v20, v19
    s_nop 1
    v_permlane16_swap_b32 v19, v20
    v_max_f32 v19, v19, v20
    v_sub_f32 v18, v16, v19
    v_mul_f32 v18, s38, v18
    v_exp_f32 v18, v18
    v_mov_b32 v16, v19
    v_sub_f32 v32, v32, v16
    v_mul_f32 v32, s38, v32
    v_exp_f32 v32, v32
    v_sub_f32 v33, v33, v16
    v_mul_f32 v33, s38, v33
    v_exp_f32 v33, v33
    v_sub_f32 v34, v34, v16
    v_mul_f32 v34, s38, v34
    v_exp_f32 v34, v34
    v_sub_f32 v35, v35, v16
    v_mul_f32 v35, s38, v35
    v_exp_f32 v35, v35
    v_sub_f32 v36, v36, v16
    v_mul_f32 v36, s38, v36
    v_exp_f32 v36, v36
    v_sub_f32 v37, v37, v16
    v_mul_f32 v37, s38, v37
    v_exp_f32 v37, v37
    v_sub_f32 v38, v38, v16
    v_mul_f32 v38, s38, v38
    v_exp_f32 v38, v38
    v_sub_f32 v39, v39, v16
    v_mul_f32 v39, s38, v39
    v_exp_f32 v39, v39
    v_mul_f32 v17, v17, v18
    v_add_f32 v17, v17, v32
    v_add_f32 v17, v17, v33
    v_add_f32 v17, v17, v34
    v_add_f32 v17, v17, v35
    v_add_f32 v17, v17, v36
    v_add_f32 v17, v17, v37
    v_add_f32 v17, v17, v38
    v_add_f32 v17, v17, v39
    v_cvt_pk_bf16_f32 v48, v32, v33
    v_cvt_pk_bf16_f32 v49, v34, v35
    v_cvt_pk_bf16_f32 v50, v36, v37
    v_cvt_pk_bf16_f32 v51, v38, v39
    v_mul_f32 v64, v64, v18
    v_mul_f32 v65, v65, v18
    v_mul_f32 v66, v66, v18
    v_mul_f32 v67, v67, v18
    v_mul_f32 v68, v68, v18
    v_mul_f32 v69, v69, v18
    v_mul_f32 v70, v70, v18
    v_mul_f32 v71, v71, v18
    v_mul_f32 v72, v72, v18
    v_mul_f32 v73, v73, v18
    v_mul_f32 v74, v74, v18
    v_mul_f32 v75, v75, v18
    v_mul_f32 v76, v76, v18
    v_mul_f32 v77, v77, v18
    v_mul_f32 v78, v78, v18
    v_mul_f32 v79, v79, v18
    v_mul_f32 v80, v80, v18
    v_mul_f32 v81, v81, v18
    v_mul_f32 v82, v82, v18
    v_mul_f32 v83, v83, v18
    v_mul_f32 v84, v84, v18
    v_mul_f32 v85, v85, v18
    v_mul_f32 v86, v86, v18
    v_mul_f32 v87, v87, v18
    v_mul_f32 v88, v88, v18
    v_mul_f32 v89, v89, v18
    v_mul_f32 v90, v90, v18
    v_mul_f32 v91, v91, v18
    v_mul_f32 v92, v92, v18
    v_mul_f32 v93, v93, v18
    v_mul_f32 v94, v94, v18
    v_mul_f32 v95, v95, v18
    s_waitcnt lgkmcnt(0)
    v_mfma_f32_16x16x32_bf16 v[64:67], a[160:163], v[48:51], v[64:67]
    v_mfma_f32_16x16x32_bf16 v[68:71], a[164:167], v[48:51], v[68:71]
    v_mfma_f32_16x16x32_bf16 v[72:75], a[168:171], v[48:51], v[72:75]
    v_mfma_f32_16x16x32_bf16 v[76:79], a[172:175], v[48:51], v[76:79]
    v_mfma_f32_16x16x32_bf16 v[80:83], a[176:179], v[48:51], v[80:83]
    v_mfma_f32_16x16x32_bf16 v[84:87], a[180:183], v[48:51], v[84:87]
    v_mfma_f32_16x16x32_bf16 v[88:91], a[184:187], v[48:51], v[88:91]
    v_mfma_f32_16x16x32_bf16 v[92:95], a[188:191], v[48:51], v[92:95]
    s_nop 7
    s_add_u32 s30, s30, 8192
    s_add_u32 s56, s56, 1
    s_cmp_lt_u32 s56, 16
    s_cbranch_scc1 L_fb_j
    v_mov_b32 v20, v17
    s_nop 1
    v_permlane32_swap_b32 v17, v20
    v_add_f32 v17, v17, v20
    v_mov_b32 v20, v17
    s_nop 1
    v_permlane16_swap_b32 v17, v20
    v_add_f32 v17, v17, v20
    v_rcp_f32 v17, v17
    s_nop 0
    v_mul_f32 v64, v64, v17
    v_mul_f32 v65, v65, v17
    v_mul_f32 v66, v66, v17
    v_mul_f32 v67, v67, v17
    v_mul_f32 v68, v68, v17
    v_mul_f32 v69, v69, v17
    v_mul_f32 v70, v70, v17
    v_mul_f32 v71, v71, v17
    v_mul_f32 v72, v72, v17
    v_mul_f32 v73, v73, v17
    v_mul_f32 v74, v74, v17
    v_mul_f32 v75, v75, v17
    v_mul_f32 v76, v76, v17
    v_mul_f32 v77, v77, v17
    v_mul_f32 v78, v78, v17
    v_mul_f32 v79, v79, v17
    v_mul_f32 v80, v80, v17
    v_mul_f32 v81, v81, v17
    v_mul_f32 v82, v82, v17
    v_mul_f32 v83, v83, v17
    v_mul_f32 v84, v84, v17
    v_mul_f32 v85, v85, v17
    v_mul_f32 v86, v86, v17
    v_mul_f32 v87, v87, v17
    v_mul_f32 v88, v88, v17
    v_mul_f32 v89, v89, v17
    v_mul_f32 v90, v90, v17
    v_mul_f32 v91, v91, v17
    v_mul_f32 v92, v92, v17
    v_mul_f32 v93, v93, v17
    v_mul_f32 v94, v94, v17
    v_mul_f32 v95, v95, v17
    v_cvt_pk_bf16_f32 v96, v64, v65
    v_cvt_pk_bf16_f32 v97, v66, v67
    v_cvt_pk_bf16_f32 v98, v68, v69
    v_cvt_pk_bf16_f32 v99, v70, v71
    v_cvt_pk_bf16_f32 v100, v72, v73
    v_cvt_pk_bf16_f32 v101, v74, v75
    v_cvt_pk_bf16_f32 v102, v76, v77
    v_cvt_pk_bf16_f32 v103, v78, v79
    v_cvt_pk_bf16_f32 v104, v80, v81
    v_cvt_pk_bf16_f32 v105, v82, v83
    v_cvt_pk_bf16_f32 v106, v84, v85
    v_cvt_pk_bf16_f32 v107, v86, v87
    v_cvt_pk_bf16_f32 v108, v88, v89
    v_cvt_pk_bf16_f32 v109, v90, v91
    v_cvt_pk_bf16_f32 v110, v92, v93
    v_cvt_pk_bf16_f32 v111, v94, v95
    buffer_store_dwordx2 v[96:97], v4, s[12:15], s40 offen offset:0
    buffer_store_dwordx2 v[98:99], v4, s[12:15], s40 offen offset:32
    buffer_store_dwordx2 v[100:101], v4, s[12:15], s40 offen offset:64
    buffer_store_dwordx2 v[102:103], v4, s[12:15], s40 offen offset:96
    buffer_store_dwordx2 v[104:105], v4, s[12:15], s40 offen offset:128
    buffer_store_dwordx2 v[106:107], v4, s[12:15], s40 offen offset:160
    buffer_store_dwordx2 v[108:109], v4, s[12:15], s40 offen offset:192
    buffer_store_dwordx2 v[110:111], v4, s[12:15], s40 offen offset:224
    s_waitcnt vmcnt(0)
    s_add_u32 s33, s33, 1
    s_cmp_lt_u32 s33, 6
    s_cbranch_scc1 L_fb_qb
L_fb_nexthead:
    s_add_u32 s37, s37, 1
    s_cmp_lt_u32 s37, 2
    s_cbranch_scc1 L_fb_head
L_end:
    s_endpgm
.section .rodata,"a"
.p2align 6
.amdhsa_kernel standalone__gqa_softmax__near_ridge_kernel
  .amdhsa_next_free_vgpr 512
  .amdhsa_next_free_sgpr 102
  .amdhsa_accum_offset 256
  .amdhsa_group_segment_fixed_size 0
  .amdhsa_kernarg_size 48
  .amdhsa_user_sgpr_count 2
  .amdhsa_user_sgpr_kernarg_segment_ptr 1
  .amdhsa_system_sgpr_workgroup_id_x 1
.end_amdhsa_kernel
```
